```python
import torch

def _softmax(x, axis=-1):
    return torch.softmax(x, dim=axis)
def _gelu(x):
    return torch.nn.functional.gelu(x, approximate="tanh")
def _silu(x):
    return torch.nn.functional.silu(x)
def _sigmoid(x):
    return torch.sigmoid(x)
def _layernorm(x, axis=-1, eps=1e-5):
    m = x.mean(dim=axis, keepdim=True)
    v = x.var(dim=axis, keepdim=True, unbiased=False)
    return (x - m) / torch.sqrt(v + eps)
def _scatter_add(tgt, idx, src, axis=0):
    return tgt.clone().index_add_(axis, idx, src)
def _segment_sum(src, seg, n):
    out = torch.zeros((n,) + src.shape[1:], dtype=src.dtype)
    return out.index_add_(0, seg, src)
def _pad(x, pw):
    flat = tuple(v for pair in reversed(pw) for v in pair)
    return torch.nn.functional.pad(x, flat)

kernel_name = 'gated_mix__spectral_gfnet__swiglu_ffn__prompt'

def setup_inputs():

    _w = (lambda a: (lambda t: t.to(torch.bfloat16) if t.is_floating_point() else t)(torch.as_tensor(a)))
    def _A_setup():
        B, S, D = 1, 2048, 512
        Df = D // 2 + 1
        return {
            "x": _w((lambda *s: torch.randn(*s, dtype=torch.bfloat16) * 0.05)(B, S, D)),
            "w_r": _w((lambda *s: torch.randn(*s, dtype=torch.bfloat16) * 0.8)(S, Df) * 0.02),
            "w_i": _w((lambda *s: torch.randn(*s, dtype=torch.bfloat16) * 0.8)(S, Df) * 0.02),
        }
    _A_in = _A_setup()

    def _B_setup():
        B, S, D, F = 1, 2048, 512, 1376
        return {
            "x": _w((lambda *s: torch.randn(*s, dtype=torch.bfloat16) * 0.05)(B, S, D)),
            "w_gate": _w((lambda *s: torch.randn(*s, dtype=torch.bfloat16) * 0.05)(D, F)),
            "w_up": _w((lambda *s: torch.randn(*s, dtype=torch.bfloat16) * 0.05)(D, F)),
            "w_down": _w((lambda *s: torch.randn(*s, dtype=torch.bfloat16) * 0.05)(F, D)),
        }
    _B_in = _B_setup()

    return {
        "A_x": _A_in["x"],
        "A_w_r": _A_in["w_r"],
        "A_w_i": _A_in["w_i"],
        "B_x": _B_in["x"],
        "B_w_gate": _B_in["w_gate"],
        "B_w_up": _B_in["w_up"],
        "B_w_down": _B_in["w_down"],
        "gate_w": _w((lambda *s: torch.randn(*s, dtype=torch.bfloat16) * 0.05)(512) * 16.0),
    }

def reference(A_x, A_w_r, A_w_i, B_x, B_w_gate, B_w_up, B_w_down, gate_w):
    def _A_ref(x, w_r, w_i):
        B, S, D = x.shape
        X = (lambda x, axes=(-2,-1): torch.fft.rfft2(x.float(), dim=axes))(x, axes=(-2, -1))
        W = w_r + 1j * w_i
        X = X * W
        y = (lambda x, s, axes=(-2,-1): torch.fft.irfft2(x, s=s, dim=axes).to(torch.bfloat16))(X, (S, D), axes=(-2, -1))
        return y

    def _B_ref(x, w_gate, w_up, w_down):
        g = _silu(x @ w_gate)
        u = x @ w_up
        return (g * u) @ w_down

    x = A_x
    g = _sigmoid((x * gate_w).sum(-1, keepdims=True))
    a = _A_ref(x, A_w_r, A_w_i)
    b = _B_ref(x, B_w_gate, B_w_up, B_w_down)
    return g * a + (1 - g) * b
```

```asm
; @launch kernel=gm_k1_kernel grid=(512,1,1) block=(256,1,1) lds=81920
; @launch kernel=gm_k2_kernel grid=(512,1,1) block=(256,1,1) lds=65536
; @launch kernel=gm_k3_kernel grid=(256,1,1) block=(256,1,1) lds=18688
.amdgcn_target "amdgcn-amd-amdhsa--gfx950"
.text
.globl gm_k1_kernel
.p2align 8
.type gm_k1_kernel,@function
gm_k1_kernel:
    s_cmp_ge_u32 s2, 512
    s_cbranch_scc1 K1_end
    s_getpc_b64 s[90:91]
    v_lshlrev_b32 v208, 7, v0
    v_min_u32 v208, K3_end-gm_k1_kernel-16, v208
    global_load_dword v208, v208, s[90:91]
    s_cmp_ge_u32 s2, 256
    s_cbranch_scc1 K1_fft
    s_setprio 3
    s_load_dwordx2 s[4:5], s[0:1], 0
    s_load_dwordx4 s[8:11], s[0:1], 32
    s_load_dwordx2 s[6:7], s[0:1], 80
    s_and_b32 s20, s2, 7
    s_lshr_b32 s21, s2, 3
    s_and_b32 s22, s20, 1
    s_lshr_b32 s23, s20, 1
    s_and_b32 s24, s21, 7
    s_lshr_b32 s25, s21, 3
    s_lshl_b32 s22, s22, 3
    s_add_u32 s22, s22, s24
    s_lshl_b32 s23, s23, 2
    s_add_u32 s23, s23, s25
    s_cmp_ge_u32 s23, 15
    s_cbranch_scc1 K1_end
    s_mul_i32 s23, s23, 96
    s_min_u32 s23, s23, 1280
    s_lshl_b32 s22, s22, 7
    v_lshrrev_b32 v2, 6, v0
    v_and_b32 v1, 63, v0
    v_readfirstlane_b32 s26, v2
    s_nop 0
    s_lshl_b32 s27, s26, 5
    s_add_u32 s27, s27, s22
    v_lshrrev_b32 v2, 2, v1
    v_lshrrev_b32 v3, 4, v1
    v_and_b32 v4, 1, v3
    v_lshlrev_b32 v4, 1, v4
    v_lshrrev_b32 v5, 1, v3
    v_mul_u32_u24 v5, 3, v5
    v_xor_b32 v4, v4, v5
    v_and_b32 v5, 3, v1
    v_xor_b32 v4, v4, v5
    v_add_u32 v2, s27, v2
    v_lshlrev_b32 v14, 10, v2
    v_lshl_add_u32 v14, v4, 4, v14
    v_add_u32 v15, 0x4000, v14
    s_lshl_b32 s28, s23, 1
    s_and_b32 s29, s26, 1
    s_mul_i32 s29, s29, 192
    v_add_u32 v2, s29, v1
    v_mul_u32_u24 v3, 0x1556, v2
    v_lshrrev_b32 v3, 16, v3
    v_mul_u32_u24 v4, 12, v3
    v_sub_u32 v4, v2, v4
    v_mul_u32_u24 v3, 2752, v3
    v_lshl_add_u32 v3, v4, 4, v3
    v_add_u32 v8, s28, v3
    v_add_u32 v2, s29, v1
    v_add_u32 v2, 64, v2
    v_mul_u32_u24 v3, 0x1556, v2
    v_lshrrev_b32 v3, 16, v3
    v_mul_u32_u24 v4, 12, v3
    v_sub_u32 v4, v2, v4
    v_mul_u32_u24 v3, 2752, v3
    v_lshl_add_u32 v3, v4, 4, v3
    v_add_u32 v9, s28, v3
    v_add_u32 v2, s29, v1
    v_add_u32 v2, 128, v2
    v_mul_u32_u24 v3, 0x1556, v2
    v_lshrrev_b32 v3, 16, v3
    v_mul_u32_u24 v4, 12, v3
    v_sub_u32 v4, v2, v4
    v_mul_u32_u24 v3, 2752, v3
    v_lshl_add_u32 v3, v4, 4, v3
    v_add_u32 v10, s28, v3
    s_lshl_b32 s30, s26, 11
    s_mul_i32 s31, s26, 3072
    s_add_u32 s31, s31, 8192
    s_and_b32 s44, s21, 15
    s_lshl_b32 s33, s44, 6
    s_mul_i32 s45, s33, 1376
    s_waitcnt lgkmcnt(0)
    s_mov_b32 s12, s4
    s_mov_b32 s13, s5
    s_mov_b32 s14, 2097152
    s_mov_b32 s15, 0x00020000
    s_cmp_ge_u32 s26, 2
    s_cselect_b32 s36, s10, s8
    s_cselect_b32 s37, s11, s9
    s_mov_b32 s38, 1409024
    s_mov_b32 s39, 0x00020000
    s_add_u32 s16, s6, 0
    s_addc_u32 s17, s7, 0
    s_mov_b32 s18, 5636096
    s_mov_b32 s19, 0x00020000
    s_add_u32 m0, s30, 0
    s_nop 0
    buffer_load_dwordx4 v14, s[12:15], s33 offen lds
    s_add_u32 m0, s30, 1024
    s_nop 0
    buffer_load_dwordx4 v15, s[12:15], s33 offen lds
    s_add_u32 m0, s31, 0
    s_nop 0
    buffer_load_dwordx4 v8, s[36:39], s45 offen lds
    s_add_u32 m0, s31, 1024
    s_nop 0
    buffer_load_dwordx4 v9, s[36:39], s45 offen lds
    s_add_u32 m0, s31, 2048
    s_add_u32 s33, s33, 64
    buffer_load_dwordx4 v10, s[36:39], s45 offen lds
    s_and_b32 s33, s33, 0x3ff
    s_mul_i32 s45, s33, 1376
    s_add_u32 m0, s30, 20480
    s_nop 0
    buffer_load_dwordx4 v14, s[12:15], s33 offen lds
    s_add_u32 m0, s30, 21504
    s_nop 0
    buffer_load_dwordx4 v15, s[12:15], s33 offen lds
    s_add_u32 m0, s31, 20480
    s_nop 0
    buffer_load_dwordx4 v8, s[36:39], s45 offen lds
    s_add_u32 m0, s31, 21504
    s_nop 0
    buffer_load_dwordx4 v9, s[36:39], s45 offen lds
    s_add_u32 m0, s31, 22528
    s_add_u32 s33, s33, 64
    buffer_load_dwordx4 v10, s[36:39], s45 offen lds
    s_and_b32 s33, s33, 0x3ff
    s_mul_i32 s45, s33, 1376
    s_add_u32 m0, s30, 40960
    s_nop 0
    buffer_load_dwordx4 v14, s[12:15], s33 offen lds
    s_add_u32 m0, s30, 41984
    s_nop 0
    buffer_load_dwordx4 v15, s[12:15], s33 offen lds
    s_add_u32 m0, s31, 40960
    s_nop 0
    buffer_load_dwordx4 v8, s[36:39], s45 offen lds
    s_add_u32 m0, s31, 41984
    s_nop 0
    buffer_load_dwordx4 v9, s[36:39], s45 offen lds
    s_add_u32 m0, s31, 43008
    s_add_u32 s33, s33, 64
    buffer_load_dwordx4 v10, s[36:39], s45 offen lds
    s_and_b32 s33, s33, 0x3ff
    s_mul_i32 s45, s33, 1376
    v_lshrrev_b32 v2, 5, v1
    v_bfe_u32 v3, v1, 2, 2
    v_lshl_add_u32 v2, v2, 3, v3
    v_mul_u32_u24 v2, 192, v2
    v_and_b32 v3, 3, v1
    v_lshl_add_u32 v2, v3, 3, v2
    v_bfe_u32 v3, v1, 4, 1
    v_lshl_add_u32 v2, v3, 5, v2
    v_add_u32 v24, 0x2000, v2
    v_add_u32 v25, 11264, v2
    v_add_u32 v26, 14336, v2
    v_add_u32 v27, 17408, v2
    v_and_b32 v2, 31, v1
    v_bfe_u32 v3, v1, 2, 2
    v_and_b32 v4, 1, v3
    v_lshlrev_b32 v4, 1, v4
    v_lshrrev_b32 v5, 1, v3
    v_mul_u32_u24 v5, 3, v5
    v_xor_b32 v4, v4, v5
    v_lshrrev_b32 v5, 5, v1
    v_xor_b32 v4, v4, v5
    v_lshlrev_b32 v6, 6, v2
    v_add_u32 v6, s30, v6
    v_lshl_add_u32 v16, v4, 4, v6
    v_xor_b32 v4, 2, v4
    v_lshl_add_u32 v17, v4, 4, v6
    s_lshr_b32 s34, s27, 4
    s_mul_i32 s34, s34, 43
    s_lshr_b32 s35, s23, 5
    s_add_u32 s34, s34, s35
    s_lshl_b32 s34, s34, 10
    v_bfe_u32 v2, v1, 4, 1
    v_mul_u32_u24 v28, 44032, v2
    v_and_b32 v2, 15, v1
    v_lshl_add_u32 v28, v2, 4, v28
    v_lshl_add_u32 v28, v5, 3, v28
    v_add_u32 v28, s34, v28
    v_mov_b32 v64, 0
    v_mov_b32 v65, 0
    v_mov_b32 v66, 0
    v_mov_b32 v67, 0
    v_mov_b32 v68, 0
    v_mov_b32 v69, 0
    v_mov_b32 v70, 0
    v_mov_b32 v71, 0
    v_mov_b32 v72, 0
    v_mov_b32 v73, 0
    v_mov_b32 v74, 0
    v_mov_b32 v75, 0
    v_mov_b32 v76, 0
    v_mov_b32 v77, 0
    v_mov_b32 v78, 0
    v_mov_b32 v79, 0
    v_mov_b32 v80, 0
    v_mov_b32 v81, 0
    v_mov_b32 v82, 0
    v_mov_b32 v83, 0
    v_mov_b32 v84, 0
    v_mov_b32 v85, 0
    v_mov_b32 v86, 0
    v_mov_b32 v87, 0
    v_mov_b32 v88, 0
    v_mov_b32 v89, 0
    v_mov_b32 v90, 0
    v_mov_b32 v91, 0
    v_mov_b32 v92, 0
    v_mov_b32 v93, 0
    v_mov_b32 v94, 0
    v_mov_b32 v95, 0
    v_mov_b32 v96, 0
    v_mov_b32 v97, 0
    v_mov_b32 v98, 0
    v_mov_b32 v99, 0
    v_mov_b32 v100, 0
    v_mov_b32 v101, 0
    v_mov_b32 v102, 0
    v_mov_b32 v103, 0
    v_mov_b32 v104, 0
    v_mov_b32 v105, 0
    v_mov_b32 v106, 0
    v_mov_b32 v107, 0
    v_mov_b32 v108, 0
    v_mov_b32 v109, 0
    v_mov_b32 v110, 0
    v_mov_b32 v111, 0
    v_mov_b32 v112, 0
    v_mov_b32 v113, 0
    v_mov_b32 v114, 0
    v_mov_b32 v115, 0
    v_mov_b32 v116, 0
    v_mov_b32 v117, 0
    v_mov_b32 v118, 0
    v_mov_b32 v119, 0
    v_mov_b32 v120, 0
    v_mov_b32 v121, 0
    v_mov_b32 v122, 0
    v_mov_b32 v123, 0
    v_mov_b32 v124, 0
    v_mov_b32 v125, 0
    v_mov_b32 v126, 0
    v_mov_b32 v127, 0
    v_mov_b32 v128, 0
    v_mov_b32 v129, 0
    v_mov_b32 v130, 0
    v_mov_b32 v131, 0
    v_mov_b32 v132, 0
    v_mov_b32 v133, 0
    v_mov_b32 v134, 0
    v_mov_b32 v135, 0
    v_mov_b32 v136, 0
    v_mov_b32 v137, 0
    v_mov_b32 v138, 0
    v_mov_b32 v139, 0
    v_mov_b32 v140, 0
    v_mov_b32 v141, 0
    v_mov_b32 v142, 0
    v_mov_b32 v143, 0
    v_mov_b32 v144, 0
    v_mov_b32 v145, 0
    v_mov_b32 v146, 0
    v_mov_b32 v147, 0
    v_mov_b32 v148, 0
    v_mov_b32 v149, 0
    v_mov_b32 v150, 0
    v_mov_b32 v151, 0
    v_mov_b32 v152, 0
    v_mov_b32 v153, 0
    v_mov_b32 v154, 0
    v_mov_b32 v155, 0
    v_mov_b32 v156, 0
    v_mov_b32 v157, 0
    v_mov_b32 v158, 0
    v_mov_b32 v159, 0
    s_waitcnt vmcnt(10)
    s_barrier
    ds_read_b128 v[160:163], v16 offset:0
    ds_read_b128 v[164:167], v17 offset:0
    ds_read_b64_tr_b16 v[176:177], v24 offset:0
    ds_read_b64_tr_b16 v[178:179], v24 offset:768
    ds_read_b64_tr_b16 v[180:181], v24 offset:64
    ds_read_b64_tr_b16 v[182:183], v24 offset:832
    ds_read_b64_tr_b16 v[184:185], v24 offset:128
    ds_read_b64_tr_b16 v[186:187], v24 offset:896
    ds_read_b64_tr_b16 v[188:189], v26 offset:0
    ds_read_b64_tr_b16 v[190:191], v26 offset:768
    ds_read_b64_tr_b16 v[192:193], v26 offset:64
    ds_read_b64_tr_b16 v[194:195], v26 offset:832
    ds_read_b64_tr_b16 v[196:197], v26 offset:128
    ds_read_b64_tr_b16 v[198:199], v26 offset:896
    s_mov_b32 s40, 0
G1_loop:
    s_waitcnt lgkmcnt(8)
    v_mfma_f32_32x32x16_bf16 v[64:79], v[176:179], v[160:163], v[64:79]
    ds_read_b64_tr_b16 v[200:201], v25 offset:0
    ds_read_b64_tr_b16 v[202:203], v25 offset:768
    v_mfma_f32_32x32x16_bf16 v[80:95], v[180:183], v[160:163], v[80:95]
    ds_read_b64_tr_b16 v[204:205], v25 offset:64
    ds_read_b64_tr_b16 v[206:207], v25 offset:832
    s_waitcnt lgkmcnt(8)
    v_mfma_f32_32x32x16_bf16 v[96:111], v[184:187], v[160:163], v[96:111]
    ds_read_b64_tr_b16 v[176:177], v25 offset:128
    ds_read_b64_tr_b16 v[178:179], v25 offset:896
    v_mfma_f32_32x32x16_bf16 v[112:127], v[188:191], v[160:163], v[112:127]
    ds_read_b64_tr_b16 v[180:181], v27 offset:0
    ds_read_b64_tr_b16 v[182:183], v27 offset:768
    s_waitcnt lgkmcnt(8)
    v_mfma_f32_32x32x16_bf16 v[128:143], v[192:195], v[160:163], v[128:143]
    ds_read_b64_tr_b16 v[184:185], v27 offset:64
    ds_read_b64_tr_b16 v[186:187], v27 offset:832
    v_mfma_f32_32x32x16_bf16 v[144:159], v[196:199], v[160:163], v[144:159]
    ds_read_b64_tr_b16 v[188:189], v27 offset:128
    ds_read_b64_tr_b16 v[190:191], v27 offset:896
    s_waitcnt lgkmcnt(8)
    v_mfma_f32_32x32x16_bf16 v[64:79], v[200:203], v[164:167], v[64:79]
    s_waitcnt vmcnt(5)
    s_barrier
    ds_read_b128 v[168:171], v16 offset:20480
    ds_read_b128 v[172:175], v17 offset:20480
    ds_read_b64_tr_b16 v[192:193], v24 offset:20480
    ds_read_b64_tr_b16 v[194:195], v24 offset:21248
    s_add_u32 m0, s30, 61440
    s_nop 0
    buffer_load_dwordx4 v14, s[12:15], s33 offen lds
    v_mfma_f32_32x32x16_bf16 v[80:95], v[204:207], v[164:167], v[80:95]
    ds_read_b64_tr_b16 v[196:197], v24 offset:20544
    ds_read_b64_tr_b16 v[198:199], v24 offset:21312
    s_add_u32 m0, s30, 62464
    s_nop 0
    buffer_load_dwordx4 v15, s[12:15], s33 offen lds
    s_waitcnt lgkmcnt(10)
    v_mfma_f32_32x32x16_bf16 v[96:111], v[176:179], v[164:167], v[96:111]
    ds_read_b64_tr_b16 v[200:201], v24 offset:20608
    ds_read_b64_tr_b16 v[202:203], v24 offset:21376
    s_add_u32 m0, s31, 61440
    s_nop 0
    buffer_load_dwordx4 v8, s[36:39], s45 offen lds
    v_mfma_f32_32x32x16_bf16 v[112:127], v[180:183], v[164:167], v[112:127]
    ds_read_b64_tr_b16 v[204:205], v26 offset:20480
    ds_read_b64_tr_b16 v[206:207], v26 offset:21248
    s_add_u32 m0, s31, 62464
    s_nop 0
    buffer_load_dwordx4 v9, s[36:39], s45 offen lds
    s_waitcnt lgkmcnt(10)
    v_mfma_f32_32x32x16_bf16 v[128:143], v[184:187], v[164:167], v[128:143]
    ds_read_b64_tr_b16 v[176:177], v26 offset:20544
    ds_read_b64_tr_b16 v[178:179], v26 offset:21312
    s_add_u32 m0, s31, 63488
    s_add_u32 s33, s33, 64
    buffer_load_dwordx4 v10, s[36:39], s45 offen lds
    s_and_b32 s33, s33, 0x3ff
    s_mul_i32 s45, s33, 1376
    v_mfma_f32_32x32x16_bf16 v[144:159], v[188:191], v[164:167], v[144:159]
    ds_read_b64_tr_b16 v[180:181], v26 offset:20608
    ds_read_b64_tr_b16 v[182:183], v26 offset:21376
    s_waitcnt lgkmcnt(8)
    v_mfma_f32_32x32x16_bf16 v[64:79], v[192:195], v[168:171], v[64:79]
    ds_read_b64_tr_b16 v[184:185], v25 offset:20480
    ds_read_b64_tr_b16 v[186:187], v25 offset:21248
    v_mfma_f32_32x32x16_bf16 v[80:95], v[196:199], v[168:171], v[80:95]
    ds_read_b64_tr_b16 v[188:189], v25 offset:20544
    ds_read_b64_tr_b16 v[190:191], v25 offset:21312
    s_waitcnt lgkmcnt(8)
    v_mfma_f32_32x32x16_bf16 v[96:111], v[200:203], v[168:171], v[96:111]
    ds_read_b64_tr_b16 v[192:193], v25 offset:20608
    ds_read_b64_tr_b16 v[194:195], v25 offset:21376
    v_mfma_f32_32x32x16_bf16 v[112:127], v[204:207], v[168:171], v[112:127]
    ds_read_b64_tr_b16 v[196:197], v27 offset:20480
    ds_read_b64_tr_b16 v[198:199], v27 offset:21248
    s_waitcnt lgkmcnt(8)
    v_mfma_f32_32x32x16_bf16 v[128:143], v[176:179], v[168:171], v[128:143]
    ds_read_b64_tr_b16 v[200:201], v27 offset:20544
    ds_read_b64_tr_b16 v[202:203], v27 offset:21312
    v_mfma_f32_32x32x16_bf16 v[144:159], v[180:183], v[168:171], v[144:159]
    ds_read_b64_tr_b16 v[204:205], v27 offset:20608
    ds_read_b64_tr_b16 v[206:207], v27 offset:21376
    s_waitcnt lgkmcnt(8)
    v_mfma_f32_32x32x16_bf16 v[64:79], v[184:187], v[172:175], v[64:79]
    s_waitcnt vmcnt(5)
    s_barrier
    ds_read_b128 v[160:163], v16 offset:40960
    ds_read_b128 v[164:167], v17 offset:40960
    ds_read_b64_tr_b16 v[176:177], v24 offset:40960
    ds_read_b64_tr_b16 v[178:179], v24 offset:41728
    s_add_u32 m0, s30, 0
    s_nop 0
    buffer_load_dwordx4 v14, s[12:15], s33 offen lds
    v_mfma_f32_32x32x16_bf16 v[80:95], v[188:191], v[172:175], v[80:95]
    ds_read_b64_tr_b16 v[180:181], v24 offset:41024
    ds_read_b64_tr_b16 v[182:183], v24 offset:41792
    s_add_u32 m0, s30, 1024
    s_nop 0
    buffer_load_dwordx4 v15, s[12:15], s33 offen lds
    s_waitcnt lgkmcnt(10)
    v_mfma_f32_32x32x16_bf16 v[96:111], v[192:195], v[172:175], v[96:111]
    ds_read_b64_tr_b16 v[184:185], v24 offset:41088
    ds_read_b64_tr_b16 v[186:187], v24 offset:41856
    s_add_u32 m0, s31, 0
    s_nop 0
    buffer_load_dwordx4 v8, s[36:39], s45 offen lds
    v_mfma_f32_32x32x16_bf16 v[112:127], v[196:199], v[172:175], v[112:127]
    ds_read_b64_tr_b16 v[188:189], v26 offset:40960
    ds_read_b64_tr_b16 v[190:191], v26 offset:41728
    s_add_u32 m0, s31, 1024
    s_nop 0
    buffer_load_dwordx4 v9, s[36:39], s45 offen lds
    s_waitcnt lgkmcnt(10)
    v_mfma_f32_32x32x16_bf16 v[128:143], v[200:203], v[172:175], v[128:143]
    ds_read_b64_tr_b16 v[192:193], v26 offset:41024
    ds_read_b64_tr_b16 v[194:195], v26 offset:41792
    s_add_u32 m0, s31, 2048
    s_add_u32 s33, s33, 64
    buffer_load_dwordx4 v10, s[36:39], s45 offen lds
    s_and_b32 s33, s33, 0x3ff
    s_mul_i32 s45, s33, 1376
    v_mfma_f32_32x32x16_bf16 v[144:159], v[204:207], v[172:175], v[144:159]
    ds_read_b64_tr_b16 v[196:197], v26 offset:41088
    ds_read_b64_tr_b16 v[198:199], v26 offset:41856
    s_waitcnt lgkmcnt(8)
    v_mfma_f32_32x32x16_bf16 v[64:79], v[176:179], v[160:163], v[64:79]
    ds_read_b64_tr_b16 v[200:201], v25 offset:40960
    ds_read_b64_tr_b16 v[202:203], v25 offset:41728
    v_mfma_f32_32x32x16_bf16 v[80:95], v[180:183], v[160:163], v[80:95]
    ds_read_b64_tr_b16 v[204:205], v25 offset:41024
    ds_read_b64_tr_b16 v[206:207], v25 offset:41792
    s_waitcnt lgkmcnt(8)
    v_mfma_f32_32x32x16_bf16 v[96:111], v[184:187], v[160:163], v[96:111]
    ds_read_b64_tr_b16 v[176:177], v25 offset:41088
    ds_read_b64_tr_b16 v[178:179], v25 offset:41856
    v_mfma_f32_32x32x16_bf16 v[112:127], v[188:191], v[160:163], v[112:127]
    ds_read_b64_tr_b16 v[180:181], v27 offset:40960
    ds_read_b64_tr_b16 v[182:183], v27 offset:41728
    s_waitcnt lgkmcnt(8)
    v_mfma_f32_32x32x16_bf16 v[128:143], v[192:195], v[160:163], v[128:143]
    ds_read_b64_tr_b16 v[184:185], v27 offset:41024
    ds_read_b64_tr_b16 v[186:187], v27 offset:41792
    v_mfma_f32_32x32x16_bf16 v[144:159], v[196:199], v[160:163], v[144:159]
    ds_read_b64_tr_b16 v[188:189], v27 offset:41088
    ds_read_b64_tr_b16 v[190:191], v27 offset:41856
    s_waitcnt lgkmcnt(8)
    v_mfma_f32_32x32x16_bf16 v[64:79], v[200:203], v[164:167], v[64:79]
    s_waitcnt vmcnt(5)
    s_barrier
    ds_read_b128 v[168:171], v16 offset:61440
    ds_read_b128 v[172:175], v17 offset:61440
    ds_read_b64_tr_b16 v[192:193], v24 offset:61440
    ds_read_b64_tr_b16 v[194:195], v24 offset:62208
    s_add_u32 m0, s30, 20480
    s_nop 0
    buffer_load_dwordx4 v14, s[12:15], s33 offen lds
    v_mfma_f32_32x32x16_bf16 v[80:95], v[204:207], v[164:167], v[80:95]
    ds_read_b64_tr_b16 v[196:197], v24 offset:61504
    ds_read_b64_tr_b16 v[198:199], v24 offset:62272
    s_add_u32 m0, s30, 21504
    s_nop 0
    buffer_load_dwordx4 v15, s[12:15], s33 offen lds
    s_waitcnt lgkmcnt(10)
    v_mfma_f32_32x32x16_bf16 v[96:111], v[176:179], v[164:167], v[96:111]
    ds_read_b64_tr_b16 v[200:201], v24 offset:61568
    ds_read_b64_tr_b16 v[202:203], v24 offset:62336
    s_add_u32 m0, s31, 20480
    s_nop 0
    buffer_load_dwordx4 v8, s[36:39], s45 offen lds
    v_mfma_f32_32x32x16_bf16 v[112:127], v[180:183], v[164:167], v[112:127]
    ds_read_b64_tr_b16 v[204:205], v26 offset:61440
    ds_read_b64_tr_b16 v[206:207], v26 offset:62208
    s_add_u32 m0, s31, 21504
    s_nop 0
    buffer_load_dwordx4 v9, s[36:39], s45 offen lds
    s_waitcnt lgkmcnt(10)
    v_mfma_f32_32x32x16_bf16 v[128:143], v[184:187], v[164:167], v[128:143]
    ds_read_b64_tr_b16 v[176:177], v26 offset:61504
    ds_read_b64_tr_b16 v[178:179], v26 offset:62272
    s_add_u32 m0, s31, 22528
    s_add_u32 s33, s33, 64
    buffer_load_dwordx4 v10, s[36:39], s45 offen lds
    s_and_b32 s33, s33, 0x3ff
    s_mul_i32 s45, s33, 1376
    v_mfma_f32_32x32x16_bf16 v[144:159], v[188:191], v[164:167], v[144:159]
    ds_read_b64_tr_b16 v[180:181], v26 offset:61568
    ds_read_b64_tr_b16 v[182:183], v26 offset:62336
    s_waitcnt lgkmcnt(8)
    v_mfma_f32_32x32x16_bf16 v[64:79], v[192:195], v[168:171], v[64:79]
    ds_read_b64_tr_b16 v[184:185], v25 offset:61440
    ds_read_b64_tr_b16 v[186:187], v25 offset:62208
    v_mfma_f32_32x32x16_bf16 v[80:95], v[196:199], v[168:171], v[80:95]
    ds_read_b64_tr_b16 v[188:189], v25 offset:61504
    ds_read_b64_tr_b16 v[190:191], v25 offset:62272
    s_waitcnt lgkmcnt(8)
    v_mfma_f32_32x32x16_bf16 v[96:111], v[200:203], v[168:171], v[96:111]
    ds_read_b64_tr_b16 v[192:193], v25 offset:61568
    ds_read_b64_tr_b16 v[194:195], v25 offset:62336
    v_mfma_f32_32x32x16_bf16 v[112:127], v[204:207], v[168:171], v[112:127]
    ds_read_b64_tr_b16 v[196:197], v27 offset:61440
    ds_read_b64_tr_b16 v[198:199], v27 offset:62208
    s_waitcnt lgkmcnt(8)
    v_mfma_f32_32x32x16_bf16 v[128:143], v[176:179], v[168:171], v[128:143]
    ds_read_b64_tr_b16 v[200:201], v27 offset:61504
    ds_read_b64_tr_b16 v[202:203], v27 offset:62272
    v_mfma_f32_32x32x16_bf16 v[144:159], v[180:183], v[168:171], v[144:159]
    ds_read_b64_tr_b16 v[204:205], v27 offset:61568
    ds_read_b64_tr_b16 v[206:207], v27 offset:62336
    s_waitcnt lgkmcnt(8)
    v_mfma_f32_32x32x16_bf16 v[64:79], v[184:187], v[172:175], v[64:79]
    s_waitcnt vmcnt(5)
    s_barrier
    ds_read_b128 v[160:163], v16 offset:0
    ds_read_b128 v[164:167], v17 offset:0
    ds_read_b64_tr_b16 v[176:177], v24 offset:0
    ds_read_b64_tr_b16 v[178:179], v24 offset:768
    s_add_u32 m0, s30, 40960
    s_nop 0
    buffer_load_dwordx4 v14, s[12:15], s33 offen lds
    v_mfma_f32_32x32x16_bf16 v[80:95], v[188:191], v[172:175], v[80:95]
    ds_read_b64_tr_b16 v[180:181], v24 offset:64
    ds_read_b64_tr_b16 v[182:183], v24 offset:832
    s_add_u32 m0, s30, 41984
    s_nop 0
    buffer_load_dwordx4 v15, s[12:15], s33 offen lds
    s_waitcnt lgkmcnt(10)
    v_mfma_f32_32x32x16_bf16 v[96:111], v[192:195], v[172:175], v[96:111]
    ds_read_b64_tr_b16 v[184:185], v24 offset:128
    ds_read_b64_tr_b16 v[186:187], v24 offset:896
    s_add_u32 m0, s31, 40960
    s_nop 0
    buffer_load_dwordx4 v8, s[36:39], s45 offen lds
    v_mfma_f32_32x32x16_bf16 v[112:127], v[196:199], v[172:175], v[112:127]
    ds_read_b64_tr_b16 v[188:189], v26 offset:0
    ds_read_b64_tr_b16 v[190:191], v26 offset:768
    s_add_u32 m0, s31, 41984
    s_nop 0
    buffer_load_dwordx4 v9, s[36:39], s45 offen lds
    s_waitcnt lgkmcnt(10)
    v_mfma_f32_32x32x16_bf16 v[128:143], v[200:203], v[172:175], v[128:143]
    ds_read_b64_tr_b16 v[192:193], v26 offset:64
    ds_read_b64_tr_b16 v[194:195], v26 offset:832
    s_add_u32 m0, s31, 43008
    s_add_u32 s33, s33, 64
    buffer_load_dwordx4 v10, s[36:39], s45 offen lds
    s_and_b32 s33, s33, 0x3ff
    s_mul_i32 s45, s33, 1376
    v_mfma_f32_32x32x16_bf16 v[144:159], v[204:207], v[172:175], v[144:159]
    ds_read_b64_tr_b16 v[196:197], v26 offset:128
    ds_read_b64_tr_b16 v[198:199], v26 offset:896
    s_add_u32 s40, s40, 1
    s_cmp_lt_u32 s40, 4
    s_cbranch_scc1 G1_loop
    s_waitcnt lgkmcnt(0)
    s_nop 15
    s_mov_b32 s40, 3216550459
    s_mov_b32 s41, 3216550459
    s_mov_b32 s42, 1.0
    s_mov_b32 s43, 1.0
    s_mov_b32 s32, 0xffff0000
    s_mov_b32 s52, s16
    s_mov_b32 s53, s17
    s_cmp_eq_u32 s23, 1280
    s_cselect_b32 s54, 0, 5636096
    s_mov_b32 s55, 0x00020000
    v_cvt_pk_bf16_f32 v160, v64, v65
    v_cvt_pk_bf16_f32 v161, v66, v67
    v_cvt_pk_bf16_f32 v162, v112, v113
    v_cvt_pk_bf16_f32 v163, v114, v115
    v_lshlrev_b32 v164, 16, v160
    v_and_b32 v165, s32, v160
    v_lshlrev_b32 v166, 16, v161
    v_and_b32 v167, s32, v161
    v_pk_mul_f32 v[172:173], v[164:165], s[40:41]
    v_pk_mul_f32 v[174:175], v[166:167], s[40:41]
    v_exp_f32 v172, v172
    v_exp_f32 v173, v173
    v_exp_f32 v174, v174
    v_exp_f32 v175, v175
    v_lshlrev_b32 v168, 16, v162
    v_and_b32 v169, s32, v162
    v_lshlrev_b32 v170, 16, v163
    v_and_b32 v171, s32, v163
    v_pk_add_f32 v[172:173], v[172:173], s[42:43]
    v_pk_add_f32 v[174:175], v[174:175], s[42:43]
    v_rcp_f32 v172, v172
    v_rcp_f32 v173, v173
    v_rcp_f32 v174, v174
    v_rcp_f32 v175, v175
    v_pk_mul_f32 v[172:173], v[172:173], v[164:165]
    v_pk_mul_f32 v[174:175], v[174:175], v[166:167]
    v_cvt_pk_bf16_f32 v160, v172, v173
    v_cvt_pk_bf16_f32 v161, v174, v175
    v_lshlrev_b32 v164, 16, v160
    v_and_b32 v165, s32, v160
    v_lshlrev_b32 v166, 16, v161
    v_and_b32 v167, s32, v161
    v_pk_mul_f32 v[164:165], v[164:165], v[168:169]
    v_pk_mul_f32 v[166:167], v[166:167], v[170:171]
    v_cvt_pk_bf16_f32 v176, v164, v165
    v_cvt_pk_bf16_f32 v177, v166, v167
    buffer_store_dwordx2 v[176:177], v28, s[52:55], 0 offen offset:0
    v_cvt_pk_bf16_f32 v180, v68, v69
    v_cvt_pk_bf16_f32 v181, v70, v71
    v_cvt_pk_bf16_f32 v182, v116, v117
    v_cvt_pk_bf16_f32 v183, v118, v119
    v_lshlrev_b32 v184, 16, v180
    v_and_b32 v185, s32, v180
    v_lshlrev_b32 v186, 16, v181
    v_and_b32 v187, s32, v181
    v_pk_mul_f32 v[192:193], v[184:185], s[40:41]
    v_pk_mul_f32 v[194:195], v[186:187], s[40:41]
    v_exp_f32 v192, v192
    v_exp_f32 v193, v193
    v_exp_f32 v194, v194
    v_exp_f32 v195, v195
    v_lshlrev_b32 v188, 16, v182
    v_and_b32 v189, s32, v182
    v_lshlrev_b32 v190, 16, v183
    v_and_b32 v191, s32, v183
    v_pk_add_f32 v[192:193], v[192:193], s[42:43]
    v_pk_add_f32 v[194:195], v[194:195], s[42:43]
    v_rcp_f32 v192, v192
    v_rcp_f32 v193, v193
    v_rcp_f32 v194, v194
    v_rcp_f32 v195, v195
    v_pk_mul_f32 v[192:193], v[192:193], v[184:185]
    v_pk_mul_f32 v[194:195], v[194:195], v[186:187]
    v_cvt_pk_bf16_f32 v180, v192, v193
    v_cvt_pk_bf16_f32 v181, v194, v195
    v_lshlrev_b32 v184, 16, v180
    v_and_b32 v185, s32, v180
    v_lshlrev_b32 v186, 16, v181
    v_and_b32 v187, s32, v181
    v_pk_mul_f32 v[184:185], v[184:185], v[188:189]
    v_pk_mul_f32 v[186:187], v[186:187], v[190:191]
    v_cvt_pk_bf16_f32 v196, v184, v185
    v_cvt_pk_bf16_f32 v197, v186, v187
    buffer_store_dwordx2 v[196:197], v28, s[52:55], 0 offen offset:256
    v_cvt_pk_bf16_f32 v160, v72, v73
    v_cvt_pk_bf16_f32 v161, v74, v75
    v_cvt_pk_bf16_f32 v162, v120, v121
    v_cvt_pk_bf16_f32 v163, v122, v123
    v_lshlrev_b32 v164, 16, v160
    v_and_b32 v165, s32, v160
    v_lshlrev_b32 v166, 16, v161
    v_and_b32 v167, s32, v161
    v_pk_mul_f32 v[172:173], v[164:165], s[40:41]
    v_pk_mul_f32 v[174:175], v[166:167], s[40:41]
    v_exp_f32 v172, v172
    v_exp_f32 v173, v173
    v_exp_f32 v174, v174
    v_exp_f32 v175, v175
    v_lshlrev_b32 v168, 16, v162
    v_and_b32 v169, s32, v162
    v_lshlrev_b32 v170, 16, v163
    v_and_b32 v171, s32, v163
    v_pk_add_f32 v[172:173], v[172:173], s[42:43]
    v_pk_add_f32 v[174:175], v[174:175], s[42:43]
    v_rcp_f32 v172, v172
    v_rcp_f32 v173, v173
    v_rcp_f32 v174, v174
    v_rcp_f32 v175, v175
    v_pk_mul_f32 v[172:173], v[172:173], v[164:165]
    v_pk_mul_f32 v[174:175], v[174:175], v[166:167]
    v_cvt_pk_bf16_f32 v160, v172, v173
    v_cvt_pk_bf16_f32 v161, v174, v175
    v_lshlrev_b32 v164, 16, v160
    v_and_b32 v165, s32, v160
    v_lshlrev_b32 v166, 16, v161
    v_and_b32 v167, s32, v161
    v_pk_mul_f32 v[164:165], v[164:165], v[168:169]
    v_pk_mul_f32 v[166:167], v[166:167], v[170:171]
    v_cvt_pk_bf16_f32 v176, v164, v165
    v_cvt_pk_bf16_f32 v177, v166, v167
    buffer_store_dwordx2 v[176:177], v28, s[52:55], 0 offen offset:512
    v_cvt_pk_bf16_f32 v180, v76, v77
    v_cvt_pk_bf16_f32 v181, v78, v79
    v_cvt_pk_bf16_f32 v182, v124, v125
    v_cvt_pk_bf16_f32 v183, v126, v127
    v_lshlrev_b32 v184, 16, v180
    v_and_b32 v185, s32, v180
    v_lshlrev_b32 v186, 16, v181
    v_and_b32 v187, s32, v181
    v_pk_mul_f32 v[192:193], v[184:185], s[40:41]
    v_pk_mul_f32 v[194:195], v[186:187], s[40:41]
    v_exp_f32 v192, v192
    v_exp_f32 v193, v193
    v_exp_f32 v194, v194
    v_exp_f32 v195, v195
    v_lshlrev_b32 v188, 16, v182
    v_and_b32 v189, s32, v182
    v_lshlrev_b32 v190, 16, v183
    v_and_b32 v191, s32, v183
    v_pk_add_f32 v[192:193], v[192:193], s[42:43]
    v_pk_add_f32 v[194:195], v[194:195], s[42:43]
    v_rcp_f32 v192, v192
    v_rcp_f32 v193, v193
    v_rcp_f32 v194, v194
    v_rcp_f32 v195, v195
    v_pk_mul_f32 v[192:193], v[192:193], v[184:185]
    v_pk_mul_f32 v[194:195], v[194:195], v[186:187]
    v_cvt_pk_bf16_f32 v180, v192, v193
    v_cvt_pk_bf16_f32 v181, v194, v195
    v_lshlrev_b32 v184, 16, v180
    v_and_b32 v185, s32, v180
    v_lshlrev_b32 v186, 16, v181
    v_and_b32 v187, s32, v181
    v_pk_mul_f32 v[184:185], v[184:185], v[188:189]
    v_pk_mul_f32 v[186:187], v[186:187], v[190:191]
    v_cvt_pk_bf16_f32 v196, v184, v185
    v_cvt_pk_bf16_f32 v197, v186, v187
    buffer_store_dwordx2 v[196:197], v28, s[52:55], 0 offen offset:768
    v_cvt_pk_bf16_f32 v160, v80, v81
    v_cvt_pk_bf16_f32 v161, v82, v83
    v_cvt_pk_bf16_f32 v162, v128, v129
    v_cvt_pk_bf16_f32 v163, v130, v131
    v_lshlrev_b32 v164, 16, v160
    v_and_b32 v165, s32, v160
    v_lshlrev_b32 v166, 16, v161
    v_and_b32 v167, s32, v161
    v_pk_mul_f32 v[172:173], v[164:165], s[40:41]
    v_pk_mul_f32 v[174:175], v[166:167], s[40:41]
    v_exp_f32 v172, v172
    v_exp_f32 v173, v173
    v_exp_f32 v174, v174
    v_exp_f32 v175, v175
    v_lshlrev_b32 v168, 16, v162
    v_and_b32 v169, s32, v162
    v_lshlrev_b32 v170, 16, v163
    v_and_b32 v171, s32, v163
    v_pk_add_f32 v[172:173], v[172:173], s[42:43]
    v_pk_add_f32 v[174:175], v[174:175], s[42:43]
    v_rcp_f32 v172, v172
    v_rcp_f32 v173, v173
    v_rcp_f32 v174, v174
    v_rcp_f32 v175, v175
    v_pk_mul_f32 v[172:173], v[172:173], v[164:165]
    v_pk_mul_f32 v[174:175], v[174:175], v[166:167]
    v_cvt_pk_bf16_f32 v160, v172, v173
    v_cvt_pk_bf16_f32 v161, v174, v175
    v_lshlrev_b32 v164, 16, v160
    v_and_b32 v165, s32, v160
    v_lshlrev_b32 v166, 16, v161
    v_and_b32 v167, s32, v161
    v_pk_mul_f32 v[164:165], v[164:165], v[168:169]
    v_pk_mul_f32 v[166:167], v[166:167], v[170:171]
    v_cvt_pk_bf16_f32 v176, v164, v165
    v_cvt_pk_bf16_f32 v177, v166, v167
    buffer_store_dwordx2 v[176:177], v28, s[52:55], 0 offen offset:1024
    v_cvt_pk_bf16_f32 v180, v84, v85
    v_cvt_pk_bf16_f32 v181, v86, v87
    v_cvt_pk_bf16_f32 v182, v132, v133
    v_cvt_pk_bf16_f32 v183, v134, v135
    v_lshlrev_b32 v184, 16, v180
    v_and_b32 v185, s32, v180
    v_lshlrev_b32 v186, 16, v181
    v_and_b32 v187, s32, v181
    v_pk_mul_f32 v[192:193], v[184:185], s[40:41]
    v_pk_mul_f32 v[194:195], v[186:187], s[40:41]
    v_exp_f32 v192, v192
    v_exp_f32 v193, v193
    v_exp_f32 v194, v194
    v_exp_f32 v195, v195
    v_lshlrev_b32 v188, 16, v182
    v_and_b32 v189, s32, v182
    v_lshlrev_b32 v190, 16, v183
    v_and_b32 v191, s32, v183
    v_pk_add_f32 v[192:193], v[192:193], s[42:43]
    v_pk_add_f32 v[194:195], v[194:195], s[42:43]
    v_rcp_f32 v192, v192
    v_rcp_f32 v193, v193
    v_rcp_f32 v194, v194
    v_rcp_f32 v195, v195
    v_pk_mul_f32 v[192:193], v[192:193], v[184:185]
    v_pk_mul_f32 v[194:195], v[194:195], v[186:187]
    v_cvt_pk_bf16_f32 v180, v192, v193
    v_cvt_pk_bf16_f32 v181, v194, v195
    v_lshlrev_b32 v184, 16, v180
    v_and_b32 v185, s32, v180
    v_lshlrev_b32 v186, 16, v181
    v_and_b32 v187, s32, v181
    v_pk_mul_f32 v[184:185], v[184:185], v[188:189]
    v_pk_mul_f32 v[186:187], v[186:187], v[190:191]
    v_cvt_pk_bf16_f32 v196, v184, v185
    v_cvt_pk_bf16_f32 v197, v186, v187
    buffer_store_dwordx2 v[196:197], v28, s[52:55], 0 offen offset:1280
    v_cvt_pk_bf16_f32 v160, v88, v89
    v_cvt_pk_bf16_f32 v161, v90, v91
    v_cvt_pk_bf16_f32 v162, v136, v137
    v_cvt_pk_bf16_f32 v163, v138, v139
    v_lshlrev_b32 v164, 16, v160
    v_and_b32 v165, s32, v160
    v_lshlrev_b32 v166, 16, v161
    v_and_b32 v167, s32, v161
    v_pk_mul_f32 v[172:173], v[164:165], s[40:41]
    v_pk_mul_f32 v[174:175], v[166:167], s[40:41]
    v_exp_f32 v172, v172
    v_exp_f32 v173, v173
    v_exp_f32 v174, v174
    v_exp_f32 v175, v175
    v_lshlrev_b32 v168, 16, v162
    v_and_b32 v169, s32, v162
    v_lshlrev_b32 v170, 16, v163
    v_and_b32 v171, s32, v163
    v_pk_add_f32 v[172:173], v[172:173], s[42:43]
    v_pk_add_f32 v[174:175], v[174:175], s[42:43]
    v_rcp_f32 v172, v172
    v_rcp_f32 v173, v173
    v_rcp_f32 v174, v174
    v_rcp_f32 v175, v175
    v_pk_mul_f32 v[172:173], v[172:173], v[164:165]
    v_pk_mul_f32 v[174:175], v[174:175], v[166:167]
    v_cvt_pk_bf16_f32 v160, v172, v173
    v_cvt_pk_bf16_f32 v161, v174, v175
    v_lshlrev_b32 v164, 16, v160
    v_and_b32 v165, s32, v160
    v_lshlrev_b32 v166, 16, v161
    v_and_b32 v167, s32, v161
    v_pk_mul_f32 v[164:165], v[164:165], v[168:169]
    v_pk_mul_f32 v[166:167], v[166:167], v[170:171]
    v_cvt_pk_bf16_f32 v176, v164, v165
    v_cvt_pk_bf16_f32 v177, v166, v167
    buffer_store_dwordx2 v[176:177], v28, s[52:55], 0 offen offset:1536
    v_cvt_pk_bf16_f32 v180, v92, v93
    v_cvt_pk_bf16_f32 v181, v94, v95
    v_cvt_pk_bf16_f32 v182, v140, v141
    v_cvt_pk_bf16_f32 v183, v142, v143
    v_lshlrev_b32 v184, 16, v180
    v_and_b32 v185, s32, v180
    v_lshlrev_b32 v186, 16, v181
    v_and_b32 v187, s32, v181
    v_pk_mul_f32 v[192:193], v[184:185], s[40:41]
    v_pk_mul_f32 v[194:195], v[186:187], s[40:41]
    v_exp_f32 v192, v192
    v_exp_f32 v193, v193
    v_exp_f32 v194, v194
    v_exp_f32 v195, v195
    v_lshlrev_b32 v188, 16, v182
    v_and_b32 v189, s32, v182
    v_lshlrev_b32 v190, 16, v183
    v_and_b32 v191, s32, v183
    v_pk_add_f32 v[192:193], v[192:193], s[42:43]
    v_pk_add_f32 v[194:195], v[194:195], s[42:43]
    v_rcp_f32 v192, v192
    v_rcp_f32 v193, v193
    v_rcp_f32 v194, v194
    v_rcp_f32 v195, v195
    v_pk_mul_f32 v[192:193], v[192:193], v[184:185]
    v_pk_mul_f32 v[194:195], v[194:195], v[186:187]
    v_cvt_pk_bf16_f32 v180, v192, v193
    v_cvt_pk_bf16_f32 v181, v194, v195
    v_lshlrev_b32 v184, 16, v180
    v_and_b32 v185, s32, v180
    v_lshlrev_b32 v186, 16, v181
    v_and_b32 v187, s32, v181
    v_pk_mul_f32 v[184:185], v[184:185], v[188:189]
    v_pk_mul_f32 v[186:187], v[186:187], v[190:191]
    v_cvt_pk_bf16_f32 v196, v184, v185
    v_cvt_pk_bf16_f32 v197, v186, v187
    buffer_store_dwordx2 v[196:197], v28, s[52:55], 0 offen offset:1792
    v_cvt_pk_bf16_f32 v160, v96, v97
    v_cvt_pk_bf16_f32 v161, v98, v99
    v_cvt_pk_bf16_f32 v162, v144, v145
    v_cvt_pk_bf16_f32 v163, v146, v147
    v_lshlrev_b32 v164, 16, v160
    v_and_b32 v165, s32, v160
    v_lshlrev_b32 v166, 16, v161
    v_and_b32 v167, s32, v161
    v_pk_mul_f32 v[172:173], v[164:165], s[40:41]
    v_pk_mul_f32 v[174:175], v[166:167], s[40:41]
    v_exp_f32 v172, v172
    v_exp_f32 v173, v173
    v_exp_f32 v174, v174
    v_exp_f32 v175, v175
    v_lshlrev_b32 v168, 16, v162
    v_and_b32 v169, s32, v162
    v_lshlrev_b32 v170, 16, v163
    v_and_b32 v171, s32, v163
    v_pk_add_f32 v[172:173], v[172:173], s[42:43]
    v_pk_add_f32 v[174:175], v[174:175], s[42:43]
    v_rcp_f32 v172, v172
    v_rcp_f32 v173, v173
    v_rcp_f32 v174, v174
    v_rcp_f32 v175, v175
    v_pk_mul_f32 v[172:173], v[172:173], v[164:165]
    v_pk_mul_f32 v[174:175], v[174:175], v[166:167]
    v_cvt_pk_bf16_f32 v160, v172, v173
    v_cvt_pk_bf16_f32 v161, v174, v175
    v_lshlrev_b32 v164, 16, v160
    v_and_b32 v165, s32, v160
    v_lshlrev_b32 v166, 16, v161
    v_and_b32 v167, s32, v161
    v_pk_mul_f32 v[164:165], v[164:165], v[168:169]
    v_pk_mul_f32 v[166:167], v[166:167], v[170:171]
    v_cvt_pk_bf16_f32 v176, v164, v165
    v_cvt_pk_bf16_f32 v177, v166, v167
    buffer_store_dwordx2 v[176:177], v28, s[16:19], 0 offen offset:2048
    v_cvt_pk_bf16_f32 v180, v100, v101
    v_cvt_pk_bf16_f32 v181, v102, v103
    v_cvt_pk_bf16_f32 v182, v148, v149
    v_cvt_pk_bf16_f32 v183, v150, v151
    v_lshlrev_b32 v184, 16, v180
    v_and_b32 v185, s32, v180
    v_lshlrev_b32 v186, 16, v181
    v_and_b32 v187, s32, v181
    v_pk_mul_f32 v[192:193], v[184:185], s[40:41]
    v_pk_mul_f32 v[194:195], v[186:187], s[40:41]
    v_exp_f32 v192, v192
    v_exp_f32 v193, v193
    v_exp_f32 v194, v194
    v_exp_f32 v195, v195
    v_lshlrev_b32 v188, 16, v182
    v_and_b32 v189, s32, v182
    v_lshlrev_b32 v190, 16, v183
    v_and_b32 v191, s32, v183
    v_pk_add_f32 v[192:193], v[192:193], s[42:43]
    v_pk_add_f32 v[194:195], v[194:195], s[42:43]
    v_rcp_f32 v192, v192
    v_rcp_f32 v193, v193
    v_rcp_f32 v194, v194
    v_rcp_f32 v195, v195
    v_pk_mul_f32 v[192:193], v[192:193], v[184:185]
    v_pk_mul_f32 v[194:195], v[194:195], v[186:187]
    v_cvt_pk_bf16_f32 v180, v192, v193
    v_cvt_pk_bf16_f32 v181, v194, v195
    v_lshlrev_b32 v184, 16, v180
    v_and_b32 v185, s32, v180
    v_lshlrev_b32 v186, 16, v181
    v_and_b32 v187, s32, v181
    v_pk_mul_f32 v[184:185], v[184:185], v[188:189]
    v_pk_mul_f32 v[186:187], v[186:187], v[190:191]
    v_cvt_pk_bf16_f32 v196, v184, v185
    v_cvt_pk_bf16_f32 v197, v186, v187
    buffer_store_dwordx2 v[196:197], v28, s[16:19], 0 offen offset:2304
    v_cvt_pk_bf16_f32 v160, v104, v105
    v_cvt_pk_bf16_f32 v161, v106, v107
    v_cvt_pk_bf16_f32 v162, v152, v153
    v_cvt_pk_bf16_f32 v163, v154, v155
    v_lshlrev_b32 v164, 16, v160
    v_and_b32 v165, s32, v160
    v_lshlrev_b32 v166, 16, v161
    v_and_b32 v167, s32, v161
    v_pk_mul_f32 v[172:173], v[164:165], s[40:41]
    v_pk_mul_f32 v[174:175], v[166:167], s[40:41]
    v_exp_f32 v172, v172
    v_exp_f32 v173, v173
    v_exp_f32 v174, v174
    v_exp_f32 v175, v175
    v_lshlrev_b32 v168, 16, v162
    v_and_b32 v169, s32, v162
    v_lshlrev_b32 v170, 16, v163
    v_and_b32 v171, s32, v163
    v_pk_add_f32 v[172:173], v[172:173], s[42:43]
    v_pk_add_f32 v[174:175], v[174:175], s[42:43]
    v_rcp_f32 v172, v172
    v_rcp_f32 v173, v173
    v_rcp_f32 v174, v174
    v_rcp_f32 v175, v175
    v_pk_mul_f32 v[172:173], v[172:173], v[164:165]
    v_pk_mul_f32 v[174:175], v[174:175], v[166:167]
    v_cvt_pk_bf16_f32 v160, v172, v173
    v_cvt_pk_bf16_f32 v161, v174, v175
    v_lshlrev_b32 v164, 16, v160
    v_and_b32 v165, s32, v160
    v_lshlrev_b32 v166, 16, v161
    v_and_b32 v167, s32, v161
    v_pk_mul_f32 v[164:165], v[164:165], v[168:169]
    v_pk_mul_f32 v[166:167], v[166:167], v[170:171]
    v_cvt_pk_bf16_f32 v176, v164, v165
    v_cvt_pk_bf16_f32 v177, v166, v167
    buffer_store_dwordx2 v[176:177], v28, s[16:19], 0 offen offset:2560
    v_cvt_pk_bf16_f32 v180, v108, v109
    v_cvt_pk_bf16_f32 v181, v110, v111
    v_cvt_pk_bf16_f32 v182, v156, v157
    v_cvt_pk_bf16_f32 v183, v158, v159
    v_lshlrev_b32 v184, 16, v180
    v_and_b32 v185, s32, v180
    v_lshlrev_b32 v186, 16, v181
    v_and_b32 v187, s32, v181
    v_pk_mul_f32 v[192:193], v[184:185], s[40:41]
    v_pk_mul_f32 v[194:195], v[186:187], s[40:41]
    v_exp_f32 v192, v192
    v_exp_f32 v193, v193
    v_exp_f32 v194, v194
    v_exp_f32 v195, v195
    v_lshlrev_b32 v188, 16, v182
    v_and_b32 v189, s32, v182
    v_lshlrev_b32 v190, 16, v183
    v_and_b32 v191, s32, v183
    v_pk_add_f32 v[192:193], v[192:193], s[42:43]
    v_pk_add_f32 v[194:195], v[194:195], s[42:43]
    v_rcp_f32 v192, v192
    v_rcp_f32 v193, v193
    v_rcp_f32 v194, v194
    v_rcp_f32 v195, v195
    v_pk_mul_f32 v[192:193], v[192:193], v[184:185]
    v_pk_mul_f32 v[194:195], v[194:195], v[186:187]
    v_cvt_pk_bf16_f32 v180, v192, v193
    v_cvt_pk_bf16_f32 v181, v194, v195
    v_lshlrev_b32 v184, 16, v180
    v_and_b32 v185, s32, v180
    v_lshlrev_b32 v186, 16, v181
    v_and_b32 v187, s32, v181
    v_pk_mul_f32 v[184:185], v[184:185], v[188:189]
    v_pk_mul_f32 v[186:187], v[186:187], v[190:191]
    v_cvt_pk_bf16_f32 v196, v184, v185
    v_cvt_pk_bf16_f32 v197, v186, v187
    buffer_store_dwordx2 v[196:197], v28, s[16:19], 0 offen offset:2816
    s_waitcnt vmcnt(0)
    s_endpgm
K1_fft:
    s_load_dwordx2 s[4:5], s[0:1], 0
    s_load_dwordx2 s[6:7], s[0:1], 8
    s_load_dwordx2 s[8:9], s[0:1], 16
    s_load_dwordx2 s[10:11], s[0:1], 80
    s_load_dwordx2 s[34:35], s[0:1], 56
    s_sub_u32 s20, s2, 256
    s_and_b32 s21, s20, 7
    s_lshr_b32 s20, s20, 3
    s_lshl_b32 s21, s21, 5
    s_add_u32 s20, s20, s21
    s_lshl_b32 s20, s20, 3
    v_lshrrev_b32 v2, 6, v0
    v_and_b32 v1, 63, v0
    v_readfirstlane_b32 s26, v2
    s_waitcnt lgkmcnt(0)
    s_mov_b32 s12, s4
    s_mov_b32 s13, s5
    s_mov_b32 s14, 2097152
    s_mov_b32 s15, 0x00020000
    s_mov_b32 s16, s34
    s_mov_b32 s17, s35
    s_mov_b32 s18, 1024
    s_mov_b32 s19, 0x00020000
    s_mov_b32 s44, s6
    s_mov_b32 s45, s7
    s_mov_b32 s46, 1052672
    s_mov_b32 s47, 0x00020000
    s_mov_b32 s48, s8
    s_mov_b32 s49, s9
    s_mov_b32 s50, 1052672
    s_mov_b32 s51, 0x00020000
    s_add_u32 s52, s10, 8388608
    s_addc_u32 s53, s11, 0
    s_mov_b32 s54, 4210688
    s_mov_b32 s55, 0x00020000
    s_add_u32 s56, s10, 25165824
    s_addc_u32 s57, s11, 0
    s_mov_b32 s58, 2105344
    s_mov_b32 s59, 0x00020000
    s_add_u32 s60, s10, 33554432
    s_addc_u32 s61, s11, 0
    s_mov_b32 s62, 8192
    s_mov_b32 s63, 0x00020000
    s_load_dwordx2 s[76:77], s[0:1], 48
    s_sub_u32 s68, s2, 256
    s_lshl_b32 s68, s68, 2
    s_add_u32 s68, s68, s26
    s_mul_i32 s68, s68, 11*128
    v_min_u32 v2, 10, v1
    v_lshlrev_b32 v2, 7, v2
    s_waitcnt lgkmcnt(0)
    s_mov_b32 s80, s76
    s_mov_b32 s81, s77
    s_mov_b32 s82, 1409024
    s_mov_b32 s83, 0x00020000
    buffer_load_dword v122, v2, s[80:83], s68 offen
    s_mov_b32 s36, 1060439283
    s_mov_b32 s37, 1060439283
    s_mov_b32 s32, 0xffff0000
    v_mov_b32 v16, 0
    v_mov_b32 v17, 0
    v_mov_b32 v18, 0
    v_mov_b32 v19, 0
    v_mov_b32 v20, 0
    v_mov_b32 v21, 0
    v_mov_b32 v22, 0
    v_mov_b32 v23, 0
    v_mov_b32 v24, 0
    v_mov_b32 v25, 0
    v_mov_b32 v26, 0
    v_mov_b32 v27, 0
    v_mov_b32 v28, 0
    v_mov_b32 v29, 0
    v_mov_b32 v30, 0
    v_mov_b32 v31, 0
    v_mov_b32 v32, 0
    v_mov_b32 v33, 0
    v_mov_b32 v34, 0
    v_mov_b32 v35, 0
    v_mov_b32 v36, 0
    v_mov_b32 v37, 0
    v_mov_b32 v38, 0
    v_mov_b32 v39, 0
    s_lshl_b32 s27, s26, 1
    s_add_u32 s27, s27, s20
    s_lshl_b32 s28, s27, 10
    v_lshlrev_b32 v9, 4, v1
    v_add_u32 v8, s28, v9
    buffer_load_dwordx4 v[100:103], v8, s[12:15], 0 offen
    buffer_load_dwordx4 v[104:107], v8, s[12:15], 0 offen offset:1024
    buffer_load_dwordx4 v[108:111], v9, s[16:19], 0 offen
    s_mul_i32 s40, s26, 4672
    v_mul_u32_u24 v5, 72, v1
    v_add_u32 v5, s40, v5
    v_lshrrev_b32 v2, 3, v1
    v_add_u32 v6, v2, v1
    v_lshlrev_b32 v6, 3, v6
    v_add_u32 v6, s40, v6
    v_mul_u32_u24 v7, 576, v2
    v_and_b32 v2, 7, v1
    v_lshl_add_u32 v7, v2, 3, v7
    v_add_u32 v7, s40, v7
    v_and_b32 v2, 7, v1
    v_cvt_f32_u32 v3, v2
    v_mul_f32 v66, 0xbc800000, v3
    v_mul_f32 v68, 0xbd000000, v3
    v_mul_f32 v70, 0xbd400000, v3
    v_mul_f32 v72, 0xbd800000, v3
    v_mul_f32 v74, 0xbda00000, v3
    v_mul_f32 v76, 0xbdc00000, v3
    v_mul_f32 v78, 0xbde00000, v3
    v_sin_f32 v67, v66
    v_cos_f32 v66, v66
    v_sin_f32 v69, v68
    v_cos_f32 v68, v68
    v_sin_f32 v71, v70
    v_cos_f32 v70, v70
    v_sin_f32 v73, v72
    v_cos_f32 v72, v72
    v_sin_f32 v75, v74
    v_cos_f32 v74, v74
    v_sin_f32 v77, v76
    v_cos_f32 v76, v76
    v_sin_f32 v79, v78
    v_cos_f32 v78, v78
    v_cvt_f32_u32 v3, v1
    v_mul_f32 v82, 0xbb000000, v3
    v_mul_f32 v84, 0xbb800000, v3
    v_mul_f32 v86, 0xbbc00000, v3
    v_mul_f32 v88, 0xbc000000, v3
    v_mul_f32 v90, 0xbc200000, v3
    v_mul_f32 v92, 0xbc400000, v3
    v_mul_f32 v94, 0xbc600000, v3
    v_sin_f32 v83, v82
    v_cos_f32 v82, v82
    v_sin_f32 v85, v84
    v_cos_f32 v84, v84
    v_sin_f32 v87, v86
    v_cos_f32 v86, v86
    v_sin_f32 v89, v88
    v_cos_f32 v88, v88
    v_sin_f32 v91, v90
    v_cos_f32 v90, v90
    v_sin_f32 v93, v92
    v_cos_f32 v92, v92
    v_sin_f32 v95, v94
    v_cos_f32 v94, v94
    s_waitcnt vmcnt(0)
    v_add_u32 v9, s40, v9
    ds_write_b128 v9, v[100:103] offset:0
    ds_write_b128 v9, v[104:107] offset:1024
    ds_write_b128 v9, v[108:111] offset:2048
    v_lshlrev_b32 v8, 1, v1
    v_add_u32 v8, s40, v8
    ds_read_u16_d16_hi v16, v8 offset:0
    ds_read_u16_d16_hi v17, v8 offset:1024
    ds_read_u16_d16_hi v32, v8 offset:2048
    ds_read_u16_d16_hi v18, v8 offset:128
    ds_read_u16_d16_hi v19, v8 offset:1152
    ds_read_u16_d16_hi v33, v8 offset:2176
    ds_read_u16_d16_hi v20, v8 offset:256
    ds_read_u16_d16_hi v21, v8 offset:1280
    ds_read_u16_d16_hi v34, v8 offset:2304
    ds_read_u16_d16_hi v22, v8 offset:384
    ds_read_u16_d16_hi v23, v8 offset:1408
    ds_read_u16_d16_hi v35, v8 offset:2432
    ds_read_u16_d16_hi v24, v8 offset:512
    ds_read_u16_d16_hi v25, v8 offset:1536
    ds_read_u16_d16_hi v36, v8 offset:2560
    ds_read_u16_d16_hi v26, v8 offset:640
    ds_read_u16_d16_hi v27, v8 offset:1664
    ds_read_u16_d16_hi v37, v8 offset:2688
    ds_read_u16_d16_hi v28, v8 offset:768
    ds_read_u16_d16_hi v29, v8 offset:1792
    ds_read_u16_d16_hi v38, v8 offset:2816
    ds_read_u16_d16_hi v30, v8 offset:896
    ds_read_u16_d16_hi v31, v8 offset:1920
    ds_read_u16_d16_hi v39, v8 offset:2944
    s_mul_i32 s29, s20, 514
    v_lshlrev_b32 v10, 4, v0
    v_add_u32 v2, s29, v10
    buffer_load_dwordx4 v[40:43], v2, s[44:47], 0 offen
    buffer_load_dwordx4 v[44:47], v2, s[48:51], 0 offen
    v_add_u32 v3, 0x1000, v2
    buffer_load_dwordx4 v[48:51], v3, s[44:47], 0 offen
    buffer_load_dwordx4 v[52:55], v3, s[48:51], 0 offen
    s_waitcnt lgkmcnt(0)
    v_mul_f32 v96, v16, v32
    v_mul_f32 v97, v17, v32
    v_cvt_pk_bf16_f32 v2, v96, v97
    v_lshlrev_b32 v56, 16, v2
    v_and_b32 v57, s32, v2
    v_mul_f32 v98, v18, v33
    v_mul_f32 v99, v19, v33
    v_cvt_pk_bf16_f32 v2, v98, v99
    v_lshlrev_b32 v98, 16, v2
    v_and_b32 v99, s32, v2
    v_pk_add_f32 v[56:57], v[56:57], v[98:99]
    v_mul_f32 v100, v20, v34
    v_mul_f32 v101, v21, v34
    v_cvt_pk_bf16_f32 v2, v100, v101
    v_lshlrev_b32 v100, 16, v2
    v_and_b32 v101, s32, v2
    v_pk_add_f32 v[56:57], v[56:57], v[100:101]
    v_mul_f32 v102, v22, v35
    v_mul_f32 v103, v23, v35
    v_cvt_pk_bf16_f32 v2, v102, v103
    v_lshlrev_b32 v102, 16, v2
    v_and_b32 v103, s32, v2
    v_pk_add_f32 v[56:57], v[56:57], v[102:103]
    v_mul_f32 v104, v24, v36
    v_mul_f32 v105, v25, v36
    v_cvt_pk_bf16_f32 v2, v104, v105
    v_lshlrev_b32 v104, 16, v2
    v_and_b32 v105, s32, v2
    v_pk_add_f32 v[56:57], v[56:57], v[104:105]
    v_mul_f32 v106, v26, v37
    v_mul_f32 v107, v27, v37
    v_cvt_pk_bf16_f32 v2, v106, v107
    v_lshlrev_b32 v106, 16, v2
    v_and_b32 v107, s32, v2
    v_pk_add_f32 v[56:57], v[56:57], v[106:107]
    v_mul_f32 v108, v28, v38
    v_mul_f32 v109, v29, v38
    v_cvt_pk_bf16_f32 v2, v108, v109
    v_lshlrev_b32 v108, 16, v2
    v_and_b32 v109, s32, v2
    v_pk_add_f32 v[56:57], v[56:57], v[108:109]
    v_mul_f32 v110, v30, v39
    v_mul_f32 v111, v31, v39
    v_cvt_pk_bf16_f32 v2, v110, v111
    v_lshlrev_b32 v110, 16, v2
    v_and_b32 v111, s32, v2
    v_pk_add_f32 v[56:57], v[56:57], v[110:111]
    s_nop 1
    v_add_f32_dpp v56, v56, v56 row_shr:1 row_mask:0xf bank_mask:0xf bound_ctrl:0
    v_add_f32_dpp v57, v57, v57 row_shr:1 row_mask:0xf bank_mask:0xf bound_ctrl:0
    s_nop 0
    v_add_f32_dpp v56, v56, v56 row_shr:2 row_mask:0xf bank_mask:0xf bound_ctrl:0
    v_add_f32_dpp v57, v57, v57 row_shr:2 row_mask:0xf bank_mask:0xf bound_ctrl:0
    s_nop 0
    v_add_f32_dpp v56, v56, v56 row_shr:4 row_mask:0xf bank_mask:0xf bound_ctrl:0
    v_add_f32_dpp v57, v57, v57 row_shr:4 row_mask:0xf bank_mask:0xf bound_ctrl:0
    s_nop 0
    v_add_f32_dpp v56, v56, v56 row_shr:8 row_mask:0xf bank_mask:0xf bound_ctrl:0
    v_add_f32_dpp v57, v57, v57 row_shr:8 row_mask:0xf bank_mask:0xf bound_ctrl:0
    s_nop 0
    v_add_f32_dpp v56, v56, v56 row_bcast:15 row_mask:0xa bank_mask:0xf
    v_add_f32_dpp v57, v57, v57 row_bcast:15 row_mask:0xa bank_mask:0xf
    s_nop 0
    v_add_f32_dpp v56, v56, v56 row_bcast:31 row_mask:0xc bank_mask:0xf
    v_add_f32_dpp v57, v57, v57 row_bcast:31 row_mask:0xc bank_mask:0xf
    v_cvt_pk_bf16_f32 v2, v56, v57
    v_lshlrev_b32 v56, 16, v2
    v_and_b32 v57, s32, v2
    s_mov_b32 s31, 1069066811
    v_mul_f32 v56, s31, v56
    v_mul_f32 v57, s31, v57
    v_exp_f32 v56, -v56
    v_exp_f32 v57, -v57
    v_add_f32 v56, 1.0, v56
    v_add_f32 v57, 1.0, v57
    v_rcp_f32 v56, v56
    v_rcp_f32 v57, v57
    s_nop 0
    v_cvt_pk_bf16_f32 v2, v56, v57
    v_lshlrev_b32 v56, 16, v2
    v_and_b32 v57, s32, v2
    v_mov_b32 v2, s27
    v_lshlrev_b32 v2, 2, v2
    v_cmp_eq_u32 vcc, 63, v1
    s_nop 0
    s_and_saveexec_b64 s[38:39], vcc
    buffer_store_dwordx2 v[56:57], v2, s[60:63], 0 offen
    s_mov_b64 exec, s[38:39]
    v_pk_add_f32 v[96:97], v[16:17], v[24:25] neg_lo:[0,1] neg_hi:[0,1]
    v_pk_add_f32 v[16:17], v[16:17], v[24:25]
    v_pk_add_f32 v[98:99], v[18:19], v[26:27] neg_lo:[0,1] neg_hi:[0,1]
    v_pk_add_f32 v[18:19], v[18:19], v[26:27]
    v_pk_add_f32 v[100:101], v[20:21], v[28:29] neg_lo:[0,1] neg_hi:[0,1]
    v_pk_add_f32 v[20:21], v[20:21], v[28:29]
    v_pk_add_f32 v[102:103], v[22:23], v[30:31] neg_lo:[0,1] neg_hi:[0,1]
    v_pk_add_f32 v[22:23], v[22:23], v[30:31]
    v_pk_add_f32 v[104:105], v[16:17], v[20:21] neg_lo:[0,1] neg_hi:[0,1]
    v_pk_add_f32 v[16:17], v[16:17], v[20:21]
    v_pk_add_f32 v[106:107], v[18:19], v[22:23] neg_lo:[0,1] neg_hi:[0,1]
    v_pk_add_f32 v[18:19], v[18:19], v[22:23]
    v_pk_add_f32 v[108:109], v[16:17], v[18:19] neg_lo:[0,1] neg_hi:[0,1]
    v_pk_add_f32 v[16:17], v[16:17], v[18:19]
    v_add_f32 v110, v104, v107
    v_sub_f32 v111, v105, v106
    v_sub_f32 v104, v104, v107
    v_add_f32 v105, v105, v106
    v_add_f32 v24, v96, v101
    v_sub_f32 v25, v97, v100
    v_sub_f32 v96, v96, v101
    v_add_f32 v97, v97, v100
    v_mov_b32 v15, v98
    v_add_f32 v98, v98, v99
    v_sub_f32 v99, v99, v15
    v_mov_b32 v15, v102
    v_add_f32 v102, -v102, v103
    v_sub_f32 v103, -v103, v15
    v_pk_add_f32 v[26:27], v[98:99], v[102:103] neg_lo:[0,1] neg_hi:[0,1]
    v_pk_add_f32 v[98:99], v[98:99], v[102:103]
    v_pk_fma_f32 v[28:29], v[98:99], s[36:37], v[24:25]
    v_pk_fma_f32 v[24:25], v[98:99], s[36:37], v[24:25] neg_lo:[1,0,0] neg_hi:[1,0,0]
    v_fma_f32 v30, v27, s36, v96
    v_fma_f32 v31, -v26, s36, v97
    v_fma_f32 v96, -v27, s36, v96
    v_fma_f32 v97, v26, s36, v97
    ds_write_b64 v5, v[16:17] offset:0
    ds_write_b64 v5, v[28:29] offset:8
    ds_write_b64 v5, v[110:111] offset:16
    ds_write_b64 v5, v[30:31] offset:24
    ds_write_b64 v5, v[108:109] offset:32
    ds_write_b64 v5, v[24:25] offset:40
    ds_write_b64 v5, v[104:105] offset:48
    ds_write_b64 v5, v[96:97] offset:56
    ds_read_b64 v[16:17], v6 offset:0
    ds_read_b64 v[28:29], v6 offset:576
    ds_read_b64 v[110:111], v6 offset:1152
    ds_read_b64 v[30:31], v6 offset:1728
    ds_read_b64 v[108:109], v6 offset:2304
    ds_read_b64 v[24:25], v6 offset:2880
    ds_read_b64 v[104:105], v6 offset:3456
    ds_read_b64 v[96:97], v6 offset:4032
    s_waitcnt lgkmcnt(0)
    v_mul_f32 v20, v29, v67
    v_mul_f32 v21, v28, v67
    v_fma_f32 v28, v28, v66, -v20
    v_fma_f32 v29, v29, v66, v21
    v_mul_f32 v22, v111, v69
    v_mul_f32 v23, v110, v69
    v_fma_f32 v110, v110, v68, -v22
    v_fma_f32 v111, v111, v68, v23
    v_mul_f32 v18, v31, v71
    v_mul_f32 v19, v30, v71
    v_fma_f32 v30, v30, v70, -v18
    v_fma_f32 v31, v31, v70, v19
    v_mul_f32 v106, v109, v73
    v_mul_f32 v107, v108, v73
    v_fma_f32 v108, v108, v72, -v106
    v_fma_f32 v109, v109, v72, v107
    v_mul_f32 v100, v25, v75
    v_mul_f32 v101, v24, v75
    v_fma_f32 v24, v24, v74, -v100
    v_fma_f32 v25, v25, v74, v101
    v_mul_f32 v102, v105, v77
    v_mul_f32 v103, v104, v77
    v_fma_f32 v104, v104, v76, -v102
    v_fma_f32 v105, v105, v76, v103
    v_mul_f32 v98, v97, v79
    v_mul_f32 v99, v96, v79
    v_fma_f32 v96, v96, v78, -v98
    v_fma_f32 v97, v97, v78, v99
    v_pk_add_f32 v[26:27], v[16:17], v[108:109] neg_lo:[0,1] neg_hi:[0,1]
    v_pk_add_f32 v[16:17], v[16:17], v[108:109]
    v_pk_add_f32 v[20:21], v[28:29], v[24:25] neg_lo:[0,1] neg_hi:[0,1]
    v_pk_add_f32 v[28:29], v[28:29], v[24:25]
    v_pk_add_f32 v[22:23], v[110:111], v[104:105] neg_lo:[0,1] neg_hi:[0,1]
    v_pk_add_f32 v[110:111], v[110:111], v[104:105]
    v_pk_add_f32 v[18:19], v[30:31], v[96:97] neg_lo:[0,1] neg_hi:[0,1]
    v_pk_add_f32 v[30:31], v[30:31], v[96:97]
    v_pk_add_f32 v[106:107], v[16:17], v[110:111] neg_lo:[0,1] neg_hi:[0,1]
    v_pk_add_f32 v[16:17], v[16:17], v[110:111]
    v_pk_add_f32 v[100:101], v[28:29], v[30:31] neg_lo:[0,1] neg_hi:[0,1]
    v_pk_add_f32 v[28:29], v[28:29], v[30:31]
    v_pk_add_f32 v[102:103], v[16:17], v[28:29] neg_lo:[0,1] neg_hi:[0,1]
    v_pk_add_f32 v[16:17], v[16:17], v[28:29]
    v_add_f32 v98, v106, v101
    v_sub_f32 v99, v107, v100
    v_sub_f32 v106, v106, v101
    v_add_f32 v107, v107, v100
    v_add_f32 v108, v26, v23
    v_sub_f32 v109, v27, v22
    v_sub_f32 v26, v26, v23
    v_add_f32 v27, v27, v22
    v_mov_b32 v15, v20
    v_add_f32 v20, v20, v21
    v_sub_f32 v21, v21, v15
    v_mov_b32 v15, v18
    v_add_f32 v18, -v18, v19
    v_sub_f32 v19, -v19, v15
    v_pk_add_f32 v[24:25], v[20:21], v[18:19] neg_lo:[0,1] neg_hi:[0,1]
    v_pk_add_f32 v[20:21], v[20:21], v[18:19]
    v_pk_fma_f32 v[104:105], v[20:21], s[36:37], v[108:109]
    v_pk_fma_f32 v[108:109], v[20:21], s[36:37], v[108:109] neg_lo:[1,0,0] neg_hi:[1,0,0]
    v_fma_f32 v96, v25, s36, v26
    v_fma_f32 v97, -v24, s36, v27
    v_fma_f32 v26, -v25, s36, v26
    v_fma_f32 v27, v24, s36, v27
    ds_write_b64 v7, v[16:17] offset:0
    ds_write_b64 v7, v[104:105] offset:72
    ds_write_b64 v7, v[98:99] offset:144
    ds_write_b64 v7, v[96:97] offset:216
    ds_write_b64 v7, v[102:103] offset:288
    ds_write_b64 v7, v[108:109] offset:360
    ds_write_b64 v7, v[106:107] offset:432
    ds_write_b64 v7, v[26:27] offset:504
    ds_read_b64 v[16:17], v6 offset:0
    ds_read_b64 v[104:105], v6 offset:576
    ds_read_b64 v[98:99], v6 offset:1152
    ds_read_b64 v[96:97], v6 offset:1728
    ds_read_b64 v[102:103], v6 offset:2304
    ds_read_b64 v[108:109], v6 offset:2880
    ds_read_b64 v[106:107], v6 offset:3456
    ds_read_b64 v[26:27], v6 offset:4032
    s_waitcnt lgkmcnt(0)
    v_mul_f32 v110, v105, v83
    v_mul_f32 v111, v104, v83
    v_fma_f32 v104, v104, v82, -v110
    v_fma_f32 v105, v105, v82, v111
    v_mul_f32 v30, v99, v85
    v_mul_f32 v31, v98, v85
    v_fma_f32 v98, v98, v84, -v30
    v_fma_f32 v99, v99, v84, v31
    v_mul_f32 v28, v97, v87
    v_mul_f32 v29, v96, v87
    v_fma_f32 v96, v96, v86, -v28
    v_fma_f32 v97, v97, v86, v29
    v_mul_f32 v100, v103, v89
    v_mul_f32 v101, v102, v89
    v_fma_f32 v102, v102, v88, -v100
    v_fma_f32 v103, v103, v88, v101
    v_mul_f32 v22, v109, v91
    v_mul_f32 v23, v108, v91
    v_fma_f32 v108, v108, v90, -v22
    v_fma_f32 v109, v109, v90, v23
    v_mul_f32 v18, v107, v93
    v_mul_f32 v19, v106, v93
    v_fma_f32 v106, v106, v92, -v18
    v_fma_f32 v107, v107, v92, v19
    v_mul_f32 v20, v27, v95
    v_mul_f32 v21, v26, v95
    v_fma_f32 v26, v26, v94, -v20
    v_fma_f32 v27, v27, v94, v21
    v_pk_add_f32 v[24:25], v[16:17], v[102:103] neg_lo:[0,1] neg_hi:[0,1]
    v_pk_add_f32 v[16:17], v[16:17], v[102:103]
    v_pk_add_f32 v[110:111], v[104:105], v[108:109] neg_lo:[0,1] neg_hi:[0,1]
    v_pk_add_f32 v[104:105], v[104:105], v[108:109]
    v_pk_add_f32 v[30:31], v[98:99], v[106:107] neg_lo:[0,1] neg_hi:[0,1]
    v_pk_add_f32 v[98:99], v[98:99], v[106:107]
    v_pk_add_f32 v[28:29], v[96:97], v[26:27] neg_lo:[0,1] neg_hi:[0,1]
    v_pk_add_f32 v[96:97], v[96:97], v[26:27]
    v_pk_add_f32 v[100:101], v[16:17], v[98:99] neg_lo:[0,1] neg_hi:[0,1]
    v_pk_add_f32 v[16:17], v[16:17], v[98:99]
    v_pk_add_f32 v[22:23], v[104:105], v[96:97] neg_lo:[0,1] neg_hi:[0,1]
    v_pk_add_f32 v[104:105], v[104:105], v[96:97]
    v_pk_add_f32 v[18:19], v[16:17], v[104:105] neg_lo:[0,1] neg_hi:[0,1]
    v_pk_add_f32 v[16:17], v[16:17], v[104:105]
    v_add_f32 v20, v100, v23
    v_sub_f32 v21, v101, v22
    v_sub_f32 v100, v100, v23
    v_add_f32 v101, v101, v22
    v_add_f32 v102, v24, v31
    v_sub_f32 v103, v25, v30
    v_sub_f32 v24, v24, v31
    v_add_f32 v25, v25, v30
    v_mov_b32 v15, v110
    v_add_f32 v110, v110, v111
    v_sub_f32 v111, v111, v15
    v_mov_b32 v15, v28
    v_add_f32 v28, -v28, v29
    v_sub_f32 v29, -v29, v15
    v_pk_add_f32 v[108:109], v[110:111], v[28:29] neg_lo:[0,1] neg_hi:[0,1]
    v_pk_add_f32 v[110:111], v[110:111], v[28:29]
    v_pk_fma_f32 v[106:107], v[110:111], s[36:37], v[102:103]
    v_pk_fma_f32 v[102:103], v[110:111], s[36:37], v[102:103] neg_lo:[1,0,0] neg_hi:[1,0,0]
    v_fma_f32 v26, v109, s36, v24
    v_fma_f32 v27, -v108, s36, v25
    v_fma_f32 v24, -v109, s36, v24
    v_fma_f32 v25, v108, s36, v25
    v_lshlrev_b32 v2, 3, v1
    v_add_u32 v2, s40, v2
    ds_write_b64 v2, v[16:17] offset:0
    ds_write_b64 v2, v[106:107] offset:512
    ds_write_b64 v2, v[20:21] offset:1024
    ds_write_b64 v2, v[26:27] offset:1536
    ds_write_b64 v2, v[18:19] offset:2048
    ds_write_b64 v2, v[102:103] offset:2560
    ds_write_b64 v2, v[100:101] offset:3072
    ds_write_b64 v2, v[24:25] offset:3584
    s_waitcnt vmcnt(0)
    ds_write_b128 v10, v[40:43] offset:18688
    ds_write_b128 v10, v[44:47] offset:22816
    v_cmp_eq_u32 vcc, 0, v0
    s_nop 0
    s_and_saveexec_b64 s[38:39], vcc
    ds_write_b128 v10, v[48:51] offset:22784
    ds_write_b128 v10, v[52:55] offset:26912
    s_mov_b64 exec, s[38:39]
    s_waitcnt lgkmcnt(0)
    s_barrier
    v_and_b32 v2, 3, v0
    v_lshrrev_b32 v3, 2, v0
    v_mul_u32_u24 v4, 4672, v2
    v_lshl_add_u32 v10, v3, 3, v4
    v_sub_u32 v11, 64, v3
    v_lshl_add_u32 v11, v11, 3, v4
    v_lshlrev_b32 v12, 14, v3
    v_lshl_add_u32 v12, v2, 4, v12
    s_lshl_b32 s29, s20, 3
    v_add_u32 v12, s29, v12
    ds_read_b64 v[16:17], v10 offset:0
    ds_read_b64 v[18:19], v10 offset:512
    ds_read_b64 v[20:21], v10 offset:1024
    ds_read_b64 v[22:23], v10 offset:1536
    v_add_u32 v3, 3584, v11
    v_cmp_gt_u32 vcc, 4, v0
    s_nop 1
    v_cndmask_b32 v3, v3, v4, vcc
    ds_read_b64 v[24:25], v3
    ds_read_b64 v[26:27], v11 offset:3072
    ds_read_b64 v[28:29], v11 offset:2560
    ds_read_b64 v[30:31], v11 offset:2048
    ds_read_b64 v[32:33], v4 offset:2048
    v_lshlrev_b32 v3, 1, v0
    ds_read_u16 v40, v3 offset:18688
    ds_read_u16 v96, v3 offset:22816
    ds_read_u16 v41, v3 offset:19202
    ds_read_u16 v97, v3 offset:23330
    ds_read_u16 v42, v3 offset:19716
    ds_read_u16 v98, v3 offset:23844
    ds_read_u16 v43, v3 offset:20230
    ds_read_u16 v99, v3 offset:24358
    ds_read_u16 v44, v3 offset:20744
    ds_read_u16 v100, v3 offset:24872
    ds_read_u16 v45, v3 offset:21258
    ds_read_u16 v101, v3 offset:25386
    ds_read_u16 v46, v3 offset:21772
    ds_read_u16 v102, v3 offset:25900
    ds_read_u16 v47, v3 offset:22286
    ds_read_u16 v103, v3 offset:26414
    s_waitcnt lgkmcnt(0)
    v_lshl_or_b32 v40, v96, 16, v40
    v_lshl_or_b32 v41, v97, 16, v41
    v_lshl_or_b32 v42, v98, 16, v42
    v_lshl_or_b32 v43, v99, 16, v43
    v_lshl_or_b32 v44, v100, 16, v44
    v_lshl_or_b32 v45, v101, 16, v45
    v_lshl_or_b32 v46, v102, 16, v46
    v_lshl_or_b32 v47, v103, 16, v47
    v_pk_add_f32 v[48:49], v[16:17], v[24:25] neg_hi:[0,1]
    v_add_f32 v50, v17, v25
    v_sub_f32 v51, v24, v16
    v_add_f32 v32, v32, v32
    v_add_f32 v33, v33, v33
    v_cmp_gt_u32 vcc, 4, v0
    s_nop 1
    v_cndmask_b32 v49, v49, v32, vcc
    v_cndmask_b32 v51, v51, v33, vcc
    s_mov_b32 s41, 0
    buffer_store_dwordx4 v[48:51], v12, s[52:55], s41 offen
    v_pk_add_f32 v[52:53], v[18:19], v[26:27] neg_hi:[0,1]
    v_add_f32 v54, v19, v27
    v_sub_f32 v55, v26, v18
    s_mov_b32 s41, 1048576
    buffer_store_dwordx4 v[52:55], v12, s[52:55], s41 offen
    v_pk_add_f32 v[56:57], v[20:21], v[28:29] neg_hi:[0,1]
    v_add_f32 v58, v21, v29
    v_sub_f32 v59, v28, v20
    s_mov_b32 s41, 2097152
    buffer_store_dwordx4 v[56:59], v12, s[52:55], s41 offen
    v_pk_add_f32 v[60:61], v[22:23], v[30:31] neg_hi:[0,1]
    v_add_f32 v62, v23, v31
    v_sub_f32 v63, v30, v22
    s_mov_b32 s41, 3145728
    buffer_store_dwordx4 v[60:63], v12, s[52:55], s41 offen
    v_lshlrev_b32 v3, 13, v0
    s_lshl_b32 s29, s20, 2
    v_add_u32 v3, s29, v3
    buffer_store_dwordx4 v[40:43], v3, s[56:59], 0 offen
    buffer_store_dwordx4 v[44:47], v3, s[56:59], 0 offen offset:16
    v_cmp_eq_u32 vcc, 0, v0
    s_nop 0
    s_and_saveexec_b64 s[38:39], vcc
    v_mov_b32 v3, 512
    ds_read_u16 v68, v3 offset:18688
    ds_read_u16 v96, v3 offset:22816
    ds_read_u16 v69, v3 offset:19202
    ds_read_u16 v97, v3 offset:23330
    ds_read_u16 v70, v3 offset:19716
    ds_read_u16 v98, v3 offset:23844
    ds_read_u16 v71, v3 offset:20230
    ds_read_u16 v99, v3 offset:24358
    ds_read_u16 v72, v3 offset:20744
    ds_read_u16 v100, v3 offset:24872
    ds_read_u16 v73, v3 offset:21258
    ds_read_u16 v101, v3 offset:25386
    ds_read_u16 v74, v3 offset:21772
    ds_read_u16 v102, v3 offset:25900
    ds_read_u16 v75, v3 offset:22286
    ds_read_u16 v103, v3 offset:26414
    v_mov_b32 v3, s29
    s_mov_b32 s41, 2097152
    s_waitcnt lgkmcnt(0)
    v_lshl_or_b32 v68, v96, 16, v68
    v_lshl_or_b32 v69, v97, 16, v69
    v_lshl_or_b32 v70, v98, 16, v70
    v_lshl_or_b32 v71, v99, 16, v71
    v_lshl_or_b32 v72, v100, 16, v72
    v_lshl_or_b32 v73, v101, 16, v73
    v_lshl_or_b32 v74, v102, 16, v74
    v_lshl_or_b32 v75, v103, 16, v75
    buffer_store_dwordx4 v[68:71], v3, s[56:59], s41 offen
    buffer_store_dwordx4 v[72:75], v3, s[56:59], s41 offen offset:16
    s_mov_b64 exec, s[38:39]
    s_waitcnt vmcnt(0)
    s_endpgm
K1_end:
    s_endpgm
.globl gm_k2_kernel
.p2align 8
.type gm_k2_kernel,@function
gm_k2_kernel:
    s_cmp_ge_u32 s2, 512
    s_cbranch_scc1 K2_end
    s_getpc_b64 s[90:91]
    v_lshlrev_b32 v228, 7, v0
    v_min_u32 v228, K2_end-gm_k2_kernel-16, v228
    global_load_dword v228, v228, s[90:91]
    s_cmp_ge_u32 s2, 256
    s_cbranch_scc1 K2_fft
    s_setprio 3
    s_load_dwordx2 s[4:5], s[0:1], 48
    s_load_dwordx2 s[10:11], s[0:1], 80
    s_and_b32 s20, s2, 7
    s_lshr_b32 s21, s2, 3
    s_lshr_b32 s22, s20, 1
    s_and_b32 s23, s20, 1
    s_and_b32 s24, s21, 7
    s_lshr_b32 s25, s21, 3
    s_lshl_b32 s22, s22, 3
    s_add_u32 s22, s22, s24
    s_lshl_b32 s22, s22, 6
    s_lshl_b32 s23, s23, 2
    s_add_u32 s23, s23, s25
    s_lshl_b32 s23, s23, 7
    v_lshrrev_b32 v2, 6, v0
    v_and_b32 v1, 63, v0
    v_readfirstlane_b32 s26, v2
    s_lshr_b32 s27, s22, 4
    s_mul_i32 s27, s27, 43
    s_add_u32 s27, s27, s26
    s_lshl_b32 s27, s27, 10
    v_bfe_u32 v2, v1, 4, 1
    v_mul_u32_u24 v8, 44032, v2
    v_lshrrev_b32 v3, 5, v1
    v_lshl_add_u32 v8, v3, 8, v8
    v_and_b32 v2, 15, v1
    v_lshl_add_u32 v8, v2, 4, v8
    v_add_u32 v8, s27, v8
    v_add_u32 v9, 88064, v8
    v_lshrrev_b32 v2, 3, v1
    v_lshlrev_b32 v2, 10, v2
    s_lshl_b32 s28, s26, 15
    s_add_u32 s28, s28, s23
    v_add_u32 v2, s28, v2
    v_and_b32 v4, 1, v1
    v_lshl_add_u32 v2, v4, 4, v2
    v_bfe_u32 v4, v1, 1, 2
    v_bfe_u32 v5, v1, 4, 1
    v_lshlrev_b32 v5, 1, v5
    v_xor_b32 v4, v4, v5
    v_lshl_add_u32 v12, v4, 5, v2
    v_add_u32 v13, 8192, v12
    v_add_u32 v14, 16384, v12
    v_add_u32 v15, 24576, v12
    s_lshl_b32 s29, s26, 14
    s_mov_b32 s30, 0
    s_mov_b32 s31, 0
    s_mov_b32 s33, s26
    s_waitcnt lgkmcnt(0)
    s_add_u32 s12, s10, 0
    s_addc_u32 s13, s11, 0
    s_mov_b32 s14, 5636096
    s_mov_b32 s15, 0x00020000
    s_mov_b32 s44, s4
    s_mov_b32 s45, s5
    s_mov_b32 s46, 1409024
    s_mov_b32 s47, 0x00020000
    s_add_u32 s48, s10, 29360128
    s_addc_u32 s49, s11, 0
    s_mov_b32 s50, 2097152
    s_mov_b32 s51, 0x00020000
    s_cmp_lt_u32 s33, 43
    s_cselect_b32 s14, 5636096, 0
    buffer_load_dwordx4 v[128:131], v8, s[12:15], s30 offen offset:0
    buffer_load_dwordx4 v[132:135], v8, s[12:15], s30 offen offset:512
    buffer_load_dwordx4 v[136:139], v9, s[12:15], s30 offen offset:0
    buffer_load_dwordx4 v[140:143], v9, s[12:15], s30 offen offset:512
    s_add_u32 m0, s29, 0
    s_add_u32 s30, s30, 4096
    buffer_load_dwordx4 v12, s[44:47], s31 offen lds
    s_add_u32 m0, s29, 1024
    s_add_u32 s33, s33, 4
    buffer_load_dwordx4 v13, s[44:47], s31 offen lds
    s_add_u32 m0, s29, 2048
    s_nop 0
    buffer_load_dwordx4 v14, s[44:47], s31 offen lds
    s_add_u32 m0, s29, 3072
    s_nop 0
    buffer_load_dwordx4 v15, s[44:47], s31 offen lds
    s_add_u32 s31, s31, 0x20000
    s_cmp_lt_u32 s33, 43
    s_cselect_b32 s14, 5636096, 0
    buffer_load_dwordx4 v[144:147], v8, s[12:15], s30 offen offset:0
    buffer_load_dwordx4 v[148:151], v8, s[12:15], s30 offen offset:512
    buffer_load_dwordx4 v[152:155], v9, s[12:15], s30 offen offset:0
    buffer_load_dwordx4 v[156:159], v9, s[12:15], s30 offen offset:512
    s_add_u32 m0, s29, 4096
    s_add_u32 s30, s30, 4096
    buffer_load_dwordx4 v12, s[44:47], s31 offen lds
    s_add_u32 m0, s29, 5120
    s_add_u32 s33, s33, 4
    buffer_load_dwordx4 v13, s[44:47], s31 offen lds
    s_add_u32 m0, s29, 6144
    s_nop 0
    buffer_load_dwordx4 v14, s[44:47], s31 offen lds
    s_add_u32 m0, s29, 7168
    s_nop 0
    buffer_load_dwordx4 v15, s[44:47], s31 offen lds
    s_add_u32 s31, s31, 0x20000
    s_cmp_lt_u32 s33, 43
    s_cselect_b32 s14, 5636096, 0
    buffer_load_dwordx4 v[160:163], v8, s[12:15], s30 offen offset:0
    buffer_load_dwordx4 v[164:167], v8, s[12:15], s30 offen offset:512
    buffer_load_dwordx4 v[168:171], v9, s[12:15], s30 offen offset:0
    buffer_load_dwordx4 v[172:175], v9, s[12:15], s30 offen offset:512
    s_add_u32 m0, s29, 8192
    s_add_u32 s30, s30, 4096
    buffer_load_dwordx4 v12, s[44:47], s31 offen lds
    s_add_u32 m0, s29, 9216
    s_add_u32 s33, s33, 4
    buffer_load_dwordx4 v13, s[44:47], s31 offen lds
    s_add_u32 m0, s29, 10240
    s_nop 0
    buffer_load_dwordx4 v14, s[44:47], s31 offen lds
    s_add_u32 m0, s29, 11264
    s_nop 0
    buffer_load_dwordx4 v15, s[44:47], s31 offen lds
    s_add_u32 s31, s31, 0x20000
    s_lshr_b32 s27, s26, 1
    s_lshl_b32 s27, s27, 5
    s_add_u32 s27, s27, s22
    v_and_b32 v2, 31, v1
    v_add_u32 v2, s27, v2
    v_lshlrev_b32 v20, 10, v2
    v_lshl_add_u32 v20, v3, 3, v20
    s_and_b32 s27, s26, 1
    s_lshl_b32 s27, s27, 6
    s_add_u32 s27, s27, s23
    v_add_u32 v20, s27, v20
    v_bfe_u32 v4, v1, 2, 2
    v_lshl_add_u32 v2, v3, 3, v4
    v_lshlrev_b32 v2, 7, v2
    v_and_b32 v4, 3, v1
    v_lshl_add_u32 v2, v4, 3, v2
    v_add_u32 v2, s29, v2
    v_bfe_u32 v4, v1, 3, 1
    v_lshlrev_b32 v4, 1, v4
    v_bfe_u32 v5, v1, 4, 1
    v_xor_b32 v4, v4, v5
    v_xor_b32 v5, 0, v4
    v_lshl_add_u32 v16, v5, 5, v2
    v_xor_b32 v5, 2, v4
    v_lshl_add_u32 v17, v5, 5, v2
    v_mov_b32 v64, 0
    v_mov_b32 v65, 0
    v_mov_b32 v66, 0
    v_mov_b32 v67, 0
    v_mov_b32 v68, 0
    v_mov_b32 v69, 0
    v_mov_b32 v70, 0
    v_mov_b32 v71, 0
    v_mov_b32 v72, 0
    v_mov_b32 v73, 0
    v_mov_b32 v74, 0
    v_mov_b32 v75, 0
    v_mov_b32 v76, 0
    v_mov_b32 v77, 0
    v_mov_b32 v78, 0
    v_mov_b32 v79, 0
    v_mov_b32 v80, 0
    v_mov_b32 v81, 0
    v_mov_b32 v82, 0
    v_mov_b32 v83, 0
    v_mov_b32 v84, 0
    v_mov_b32 v85, 0
    v_mov_b32 v86, 0
    v_mov_b32 v87, 0
    v_mov_b32 v88, 0
    v_mov_b32 v89, 0
    v_mov_b32 v90, 0
    v_mov_b32 v91, 0
    v_mov_b32 v92, 0
    v_mov_b32 v93, 0
    v_mov_b32 v94, 0
    v_mov_b32 v95, 0
    v_mov_b32 v96, 0
    v_mov_b32 v97, 0
    v_mov_b32 v98, 0
    v_mov_b32 v99, 0
    v_mov_b32 v100, 0
    v_mov_b32 v101, 0
    v_mov_b32 v102, 0
    v_mov_b32 v103, 0
    v_mov_b32 v104, 0
    v_mov_b32 v105, 0
    v_mov_b32 v106, 0
    v_mov_b32 v107, 0
    v_mov_b32 v108, 0
    v_mov_b32 v109, 0
    v_mov_b32 v110, 0
    v_mov_b32 v111, 0
    v_mov_b32 v112, 0
    v_mov_b32 v113, 0
    v_mov_b32 v114, 0
    v_mov_b32 v115, 0
    v_mov_b32 v116, 0
    v_mov_b32 v117, 0
    v_mov_b32 v118, 0
    v_mov_b32 v119, 0
    v_mov_b32 v120, 0
    v_mov_b32 v121, 0
    v_mov_b32 v122, 0
    v_mov_b32 v123, 0
    v_mov_b32 v124, 0
    v_mov_b32 v125, 0
    v_mov_b32 v126, 0
    v_mov_b32 v127, 0
    s_waitcnt vmcnt(16)
    ds_read_b64_tr_b16 v[192:193], v16 offset:0
    ds_read_b64_tr_b16 v[194:195], v16 offset:512
    ds_read_b64_tr_b16 v[196:197], v16 offset:2048
    ds_read_b64_tr_b16 v[198:199], v16 offset:2560
    ds_read_b64_tr_b16 v[200:201], v17 offset:0
    ds_read_b64_tr_b16 v[202:203], v17 offset:512
    ds_read_b64_tr_b16 v[204:205], v17 offset:2048
    ds_read_b64_tr_b16 v[206:207], v17 offset:2560
    s_mov_b32 s40, 0
G2_loop:
    s_waitcnt lgkmcnt(0)
    v_mfma_f32_32x32x16_bf16 v[64:79], v[192:195], v[128:131], v[64:79]
    s_cmp_lt_u32 s33, 43
    s_cselect_b32 s14, 5636096, 0
    buffer_load_dwordx4 v[176:179], v8, s[12:15], s30 offen offset:0
    v_mfma_f32_32x32x16_bf16 v[80:95], v[200:203], v[128:131], v[80:95]
    buffer_load_dwordx4 v[180:183], v8, s[12:15], s30 offen offset:512
    v_mfma_f32_32x32x16_bf16 v[96:111], v[192:195], v[136:139], v[96:111]
    buffer_load_dwordx4 v[184:187], v9, s[12:15], s30 offen offset:0
    v_mfma_f32_32x32x16_bf16 v[112:127], v[200:203], v[136:139], v[112:127]
    buffer_load_dwordx4 v[188:191], v9, s[12:15], s30 offen offset:512
    s_waitcnt vmcnt(12)
    ds_read_b64_tr_b16 v[208:209], v16 offset:4096
    ds_read_b64_tr_b16 v[210:211], v16 offset:4608
    ds_read_b64_tr_b16 v[212:213], v16 offset:6144
    ds_read_b64_tr_b16 v[214:215], v16 offset:6656
    ds_read_b64_tr_b16 v[216:217], v17 offset:4096
    ds_read_b64_tr_b16 v[218:219], v17 offset:4608
    ds_read_b64_tr_b16 v[220:221], v17 offset:6144
    ds_read_b64_tr_b16 v[222:223], v17 offset:6656
    v_mfma_f32_32x32x16_bf16 v[64:79], v[196:199], v[132:135], v[64:79]
    s_add_u32 m0, s29, 12288
    s_add_u32 s30, s30, 4096
    buffer_load_dwordx4 v12, s[44:47], s31 offen lds
    v_mfma_f32_32x32x16_bf16 v[80:95], v[204:207], v[132:135], v[80:95]
    s_add_u32 m0, s29, 13312
    s_add_u32 s33, s33, 4
    buffer_load_dwordx4 v13, s[44:47], s31 offen lds
    v_mfma_f32_32x32x16_bf16 v[96:111], v[196:199], v[140:143], v[96:111]
    s_add_u32 m0, s29, 14336
    s_nop 0
    buffer_load_dwordx4 v14, s[44:47], s31 offen lds
    v_mfma_f32_32x32x16_bf16 v[112:127], v[204:207], v[140:143], v[112:127]
    s_add_u32 m0, s29, 15360
    s_nop 0
    buffer_load_dwordx4 v15, s[44:47], s31 offen lds
    s_add_u32 s31, s31, 0x20000
    s_waitcnt lgkmcnt(0)
    v_mfma_f32_32x32x16_bf16 v[64:79], v[208:211], v[144:147], v[64:79]
    s_cmp_lt_u32 s33, 43
    s_cselect_b32 s14, 5636096, 0
    buffer_load_dwordx4 v[128:131], v8, s[12:15], s30 offen offset:0
    v_mfma_f32_32x32x16_bf16 v[80:95], v[216:219], v[144:147], v[80:95]
    buffer_load_dwordx4 v[132:135], v8, s[12:15], s30 offen offset:512
    v_mfma_f32_32x32x16_bf16 v[96:111], v[208:211], v[152:155], v[96:111]
    buffer_load_dwordx4 v[136:139], v9, s[12:15], s30 offen offset:0
    v_mfma_f32_32x32x16_bf16 v[112:127], v[216:219], v[152:155], v[112:127]
    buffer_load_dwordx4 v[140:143], v9, s[12:15], s30 offen offset:512
    s_waitcnt vmcnt(12)
    ds_read_b64_tr_b16 v[192:193], v16 offset:8192
    ds_read_b64_tr_b16 v[194:195], v16 offset:8704
    ds_read_b64_tr_b16 v[196:197], v16 offset:10240
    ds_read_b64_tr_b16 v[198:199], v16 offset:10752
    ds_read_b64_tr_b16 v[200:201], v17 offset:8192
    ds_read_b64_tr_b16 v[202:203], v17 offset:8704
    ds_read_b64_tr_b16 v[204:205], v17 offset:10240
    ds_read_b64_tr_b16 v[206:207], v17 offset:10752
    v_mfma_f32_32x32x16_bf16 v[64:79], v[212:215], v[148:151], v[64:79]
    s_add_u32 m0, s29, 0
    s_add_u32 s30, s30, 4096
    buffer_load_dwordx4 v12, s[44:47], s31 offen lds
    v_mfma_f32_32x32x16_bf16 v[80:95], v[220:223], v[148:151], v[80:95]
    s_add_u32 m0, s29, 1024
    s_add_u32 s33, s33, 4
    buffer_load_dwordx4 v13, s[44:47], s31 offen lds
    v_mfma_f32_32x32x16_bf16 v[96:111], v[212:215], v[156:159], v[96:111]
    s_add_u32 m0, s29, 2048
    s_nop 0
    buffer_load_dwordx4 v14, s[44:47], s31 offen lds
    v_mfma_f32_32x32x16_bf16 v[112:127], v[220:223], v[156:159], v[112:127]
    s_add_u32 m0, s29, 3072
    s_nop 0
    buffer_load_dwordx4 v15, s[44:47], s31 offen lds
    s_add_u32 s31, s31, 0x20000
    s_waitcnt lgkmcnt(0)
    v_mfma_f32_32x32x16_bf16 v[64:79], v[192:195], v[160:163], v[64:79]
    s_cmp_lt_u32 s33, 43
    s_cselect_b32 s14, 5636096, 0
    buffer_load_dwordx4 v[144:147], v8, s[12:15], s30 offen offset:0
    v_mfma_f32_32x32x16_bf16 v[80:95], v[200:203], v[160:163], v[80:95]
    buffer_load_dwordx4 v[148:151], v8, s[12:15], s30 offen offset:512
    v_mfma_f32_32x32x16_bf16 v[96:111], v[192:195], v[168:171], v[96:111]
    buffer_load_dwordx4 v[152:155], v9, s[12:15], s30 offen offset:0
    v_mfma_f32_32x32x16_bf16 v[112:127], v[200:203], v[168:171], v[112:127]
    buffer_load_dwordx4 v[156:159], v9, s[12:15], s30 offen offset:512
    s_waitcnt vmcnt(12)
    ds_read_b64_tr_b16 v[208:209], v16 offset:12288
    ds_read_b64_tr_b16 v[210:211], v16 offset:12800
    ds_read_b64_tr_b16 v[212:213], v16 offset:14336
    ds_read_b64_tr_b16 v[214:215], v16 offset:14848
    ds_read_b64_tr_b16 v[216:217], v17 offset:12288
    ds_read_b64_tr_b16 v[218:219], v17 offset:12800
    ds_read_b64_tr_b16 v[220:221], v17 offset:14336
    ds_read_b64_tr_b16 v[222:223], v17 offset:14848
    v_mfma_f32_32x32x16_bf16 v[64:79], v[196:199], v[164:167], v[64:79]
    s_add_u32 m0, s29, 4096
    s_add_u32 s30, s30, 4096
    buffer_load_dwordx4 v12, s[44:47], s31 offen lds
    v_mfma_f32_32x32x16_bf16 v[80:95], v[204:207], v[164:167], v[80:95]
    s_add_u32 m0, s29, 5120
    s_add_u32 s33, s33, 4
    buffer_load_dwordx4 v13, s[44:47], s31 offen lds
    v_mfma_f32_32x32x16_bf16 v[96:111], v[196:199], v[172:175], v[96:111]
    s_add_u32 m0, s29, 6144
    s_nop 0
    buffer_load_dwordx4 v14, s[44:47], s31 offen lds
    v_mfma_f32_32x32x16_bf16 v[112:127], v[204:207], v[172:175], v[112:127]
    s_add_u32 m0, s29, 7168
    s_nop 0
    buffer_load_dwordx4 v15, s[44:47], s31 offen lds
    s_add_u32 s31, s31, 0x20000
    s_waitcnt lgkmcnt(0)
    v_mfma_f32_32x32x16_bf16 v[64:79], v[208:211], v[176:179], v[64:79]
    s_cmp_lt_u32 s33, 43
    s_cselect_b32 s14, 5636096, 0
    buffer_load_dwordx4 v[160:163], v8, s[12:15], s30 offen offset:0
    v_mfma_f32_32x32x16_bf16 v[80:95], v[216:219], v[176:179], v[80:95]
    buffer_load_dwordx4 v[164:167], v8, s[12:15], s30 offen offset:512
    v_mfma_f32_32x32x16_bf16 v[96:111], v[208:211], v[184:187], v[96:111]
    buffer_load_dwordx4 v[168:171], v9, s[12:15], s30 offen offset:0
    v_mfma_f32_32x32x16_bf16 v[112:127], v[216:219], v[184:187], v[112:127]
    buffer_load_dwordx4 v[172:175], v9, s[12:15], s30 offen offset:512
    s_waitcnt vmcnt(12)
    ds_read_b64_tr_b16 v[192:193], v16 offset:0
    ds_read_b64_tr_b16 v[194:195], v16 offset:512
    ds_read_b64_tr_b16 v[196:197], v16 offset:2048
    ds_read_b64_tr_b16 v[198:199], v16 offset:2560
    ds_read_b64_tr_b16 v[200:201], v17 offset:0
    ds_read_b64_tr_b16 v[202:203], v17 offset:512
    ds_read_b64_tr_b16 v[204:205], v17 offset:2048
    ds_read_b64_tr_b16 v[206:207], v17 offset:2560
    v_mfma_f32_32x32x16_bf16 v[64:79], v[212:215], v[180:183], v[64:79]
    s_add_u32 m0, s29, 8192
    s_add_u32 s30, s30, 4096
    buffer_load_dwordx4 v12, s[44:47], s31 offen lds
    v_mfma_f32_32x32x16_bf16 v[80:95], v[220:223], v[180:183], v[80:95]
    s_add_u32 m0, s29, 9216
    s_add_u32 s33, s33, 4
    buffer_load_dwordx4 v13, s[44:47], s31 offen lds
    v_mfma_f32_32x32x16_bf16 v[96:111], v[212:215], v[188:191], v[96:111]
    s_add_u32 m0, s29, 10240
    s_nop 0
    buffer_load_dwordx4 v14, s[44:47], s31 offen lds
    v_mfma_f32_32x32x16_bf16 v[112:127], v[220:223], v[188:191], v[112:127]
    s_add_u32 m0, s29, 11264
    s_nop 0
    buffer_load_dwordx4 v15, s[44:47], s31 offen lds
    s_add_u32 s31, s31, 0x20000
    s_add_u32 s40, s40, 1
    s_cmp_lt_u32 s40, 3
    s_cbranch_scc1 G2_loop
    s_waitcnt vmcnt(0) lgkmcnt(0)
    s_nop 7
    v_lshlrev_b32 v2, 4, v1
    v_add_u32 v3, s29, v2
    ds_write_b128 v3, v[64:67] offset:0
    ds_write_b128 v3, v[68:71] offset:1024
    ds_write_b128 v3, v[72:75] offset:2048
    ds_write_b128 v3, v[76:79] offset:3072
    ds_write_b128 v3, v[80:83] offset:4096
    ds_write_b128 v3, v[84:87] offset:5120
    ds_write_b128 v3, v[88:91] offset:6144
    ds_write_b128 v3, v[92:95] offset:7168
    ds_write_b128 v3, v[96:99] offset:8192
    ds_write_b128 v3, v[100:103] offset:9216
    ds_write_b128 v3, v[104:107] offset:10240
    ds_write_b128 v3, v[108:111] offset:11264
    ds_write_b128 v3, v[112:115] offset:12288
    ds_write_b128 v3, v[116:119] offset:13312
    ds_write_b128 v3, v[120:123] offset:14336
    ds_write_b128 v3, v[124:127] offset:15360
    s_waitcnt lgkmcnt(0)
    s_barrier
    s_lshl_b32 s27, s26, 12
    v_add_u32 v3, s27, v2
    ds_read_b128 v[128:131], v3 offset:0
    ds_read_b128 v[132:135], v3 offset:1024
    ds_read_b128 v[136:139], v3 offset:2048
    ds_read_b128 v[140:143], v3 offset:3072
    ds_read_b128 v[144:147], v3 offset:16384
    ds_read_b128 v[148:151], v3 offset:17408
    ds_read_b128 v[152:155], v3 offset:18432
    ds_read_b128 v[156:159], v3 offset:19456
    ds_read_b128 v[160:163], v3 offset:32768
    ds_read_b128 v[164:167], v3 offset:33792
    ds_read_b128 v[168:171], v3 offset:34816
    ds_read_b128 v[172:175], v3 offset:35840
    ds_read_b128 v[176:179], v3 offset:49152
    ds_read_b128 v[180:183], v3 offset:50176
    ds_read_b128 v[184:187], v3 offset:51200
    ds_read_b128 v[188:191], v3 offset:52224
    s_waitcnt lgkmcnt(0)
    v_pk_add_f32 v[128:129], v[128:129], v[144:145]
    v_pk_add_f32 v[160:161], v[160:161], v[176:177]
    v_pk_add_f32 v[128:129], v[128:129], v[160:161]
    v_pk_add_f32 v[130:131], v[130:131], v[146:147]
    v_pk_add_f32 v[162:163], v[162:163], v[178:179]
    v_pk_add_f32 v[130:131], v[130:131], v[162:163]
    v_cvt_pk_bf16_f32 v192, v128, v129
    v_cvt_pk_bf16_f32 v193, v130, v131
    buffer_store_dwordx2 v[192:193], v20, s[48:51], 0 offen offset:0
    v_pk_add_f32 v[132:133], v[132:133], v[148:149]
    v_pk_add_f32 v[164:165], v[164:165], v[180:181]
    v_pk_add_f32 v[132:133], v[132:133], v[164:165]
    v_pk_add_f32 v[134:135], v[134:135], v[150:151]
    v_pk_add_f32 v[166:167], v[166:167], v[182:183]
    v_pk_add_f32 v[134:135], v[134:135], v[166:167]
    v_cvt_pk_bf16_f32 v194, v132, v133
    v_cvt_pk_bf16_f32 v195, v134, v135
    buffer_store_dwordx2 v[194:195], v20, s[48:51], 0 offen offset:16
    v_pk_add_f32 v[136:137], v[136:137], v[152:153]
    v_pk_add_f32 v[168:169], v[168:169], v[184:185]
    v_pk_add_f32 v[136:137], v[136:137], v[168:169]
    v_pk_add_f32 v[138:139], v[138:139], v[154:155]
    v_pk_add_f32 v[170:171], v[170:171], v[186:187]
    v_pk_add_f32 v[138:139], v[138:139], v[170:171]
    v_cvt_pk_bf16_f32 v196, v136, v137
    v_cvt_pk_bf16_f32 v197, v138, v139
    buffer_store_dwordx2 v[196:197], v20, s[48:51], 0 offen offset:32
    v_pk_add_f32 v[140:141], v[140:141], v[156:157]
    v_pk_add_f32 v[172:173], v[172:173], v[188:189]
    v_pk_add_f32 v[140:141], v[140:141], v[172:173]
    v_pk_add_f32 v[142:143], v[142:143], v[158:159]
    v_pk_add_f32 v[174:175], v[174:175], v[190:191]
    v_pk_add_f32 v[142:143], v[142:143], v[174:175]
    v_cvt_pk_bf16_f32 v198, v140, v141
    v_cvt_pk_bf16_f32 v199, v142, v143
    buffer_store_dwordx2 v[198:199], v20, s[48:51], 0 offen offset:48
    s_waitcnt vmcnt(0)
    s_endpgm
K2_fft:
    s_load_dwordx2 s[10:11], s[0:1], 80
    s_sub_u32 s20, s2, 256
    s_lshl_b32 s21, s20, 14
    s_lshl_b32 s22, s20, 13
    s_add_u32 s23, s21, 8388608
    s_add_u32 s24, s21, 16777216
    s_add_u32 s25, s22, 25165824
    s_waitcnt lgkmcnt(0)
    s_add_u32 s12, s10, s23
    s_addc_u32 s13, s11, 0
    s_mov_b32 s14, 16384
    s_mov_b32 s15, 0x00020000
    s_add_u32 s16, s10, s24
    s_addc_u32 s17, s11, 0
    s_mov_b32 s18, 16384
    s_mov_b32 s19, 0x00020000
    s_add_u32 s44, s10, s25
    s_addc_u32 s45, s11, 0
    s_mov_b32 s46, 8192
    s_mov_b32 s47, 0x00020000
    s_mov_b32 s36, 1060439283
    s_mov_b32 s37, 1060439283
    s_mov_b32 s34, 889192448
    s_mov_b32 s35, 889192448
    s_mov_b32 s32, 0xffff0000
    v_lshlrev_b32 v5, 3, v0
    v_lshlrev_b32 v6, 2, v0
    s_movk_i32 s48, 0x1000
    s_movk_i32 s49, 0x2000
    s_movk_i32 s50, 0x3000
    buffer_load_dwordx2 v[16:17], v5, s[12:15], 0 offen offset:0
    buffer_load_dwordx2 v[18:19], v5, s[12:15], 0 offen offset:2048
    buffer_load_dwordx2 v[20:21], v5, s[12:15], s48 offen offset:0
    buffer_load_dwordx2 v[22:23], v5, s[12:15], s48 offen offset:2048
    buffer_load_dwordx2 v[24:25], v5, s[12:15], s49 offen offset:0
    buffer_load_dwordx2 v[26:27], v5, s[12:15], s49 offen offset:2048
    buffer_load_dwordx2 v[28:29], v5, s[12:15], s50 offen offset:0
    buffer_load_dwordx2 v[30:31], v5, s[12:15], s50 offen offset:2048
    buffer_load_dword v32, v6, s[44:47], 0 offen offset:0
    buffer_load_dword v33, v6, s[44:47], 0 offen offset:1024
    buffer_load_dword v34, v6, s[44:47], 0 offen offset:2048
    buffer_load_dword v35, v6, s[44:47], 0 offen offset:3072
    buffer_load_dword v36, v6, s[44:47], s48 offen offset:0
    buffer_load_dword v37, v6, s[44:47], s48 offen offset:1024
    buffer_load_dword v38, v6, s[44:47], s48 offen offset:2048
    buffer_load_dword v39, v6, s[44:47], s48 offen offset:3072
    v_mul_u32_u24 v7, 72, v0
    v_lshrrev_b32 v2, 3, v0
    v_add_u32 v8, v2, v0
    v_lshlrev_b32 v8, 3, v8
    v_mul_u32_u24 v9, 576, v2
    v_and_b32 v3, 7, v0
    v_lshl_add_u32 v9, v3, 3, v9
    v_lshrrev_b32 v2, 6, v0
    v_mul_u32_u24 v10, 4608, v2
    v_and_b32 v2, 63, v0
    v_lshrrev_b32 v4, 3, v2
    v_add_u32 v4, v4, v2
    v_lshl_add_u32 v10, v4, 3, v10
    v_cvt_f32_u32 v12, v3
    v_mul_f32 v42, 0xbc800000, v12
    v_mul_f32 v44, 0xbd000000, v12
    v_mul_f32 v46, 0xbd400000, v12
    v_mul_f32 v48, 0xbd800000, v12
    v_mul_f32 v50, 0xbda00000, v12
    v_mul_f32 v52, 0xbdc00000, v12
    v_mul_f32 v54, 0xbde00000, v12
    v_sin_f32 v43, v42
    v_cos_f32 v42, v42
    v_sin_f32 v45, v44
    v_cos_f32 v44, v44
    v_sin_f32 v47, v46
    v_cos_f32 v46, v46
    v_sin_f32 v49, v48
    v_cos_f32 v48, v48
    v_sin_f32 v51, v50
    v_cos_f32 v50, v50
    v_sin_f32 v53, v52
    v_cos_f32 v52, v52
    v_sin_f32 v55, v54
    v_cos_f32 v54, v54
    v_cvt_f32_u32 v12, v2
    v_mul_f32 v58, 0xbb000000, v12
    v_mul_f32 v60, 0xbb800000, v12
    v_mul_f32 v62, 0xbbc00000, v12
    v_mul_f32 v64, 0xbc000000, v12
    v_mul_f32 v66, 0xbc200000, v12
    v_mul_f32 v68, 0xbc400000, v12
    v_mul_f32 v70, 0xbc600000, v12
    v_sin_f32 v59, v58
    v_cos_f32 v58, v58
    v_sin_f32 v61, v60
    v_cos_f32 v60, v60
    v_sin_f32 v63, v62
    v_cos_f32 v62, v62
    v_sin_f32 v65, v64
    v_cos_f32 v64, v64
    v_sin_f32 v67, v66
    v_cos_f32 v66, v66
    v_sin_f32 v69, v68
    v_cos_f32 v68, v68
    v_sin_f32 v71, v70
    v_cos_f32 v70, v70
    v_cvt_f32_u32 v12, v0
    v_mul_f32 v74, 0xba000000, v12
    v_mul_f32 v76, 0xba800000, v12
    v_mul_f32 v78, 0xbac00000, v12
    v_sin_f32 v75, v74
    v_cos_f32 v74, v74
    v_sin_f32 v77, v76
    v_cos_f32 v76, v76
    v_sin_f32 v79, v78
    v_cos_f32 v78, v78
    v_add_u32 v2, 256, v0
    v_cvt_f32_u32 v12, v2
    v_mul_f32 v82, 0xba000000, v12
    v_mul_f32 v84, 0xba800000, v12
    v_mul_f32 v86, 0xbac00000, v12
    v_sin_f32 v83, v82
    v_cos_f32 v82, v82
    v_sin_f32 v85, v84
    v_cos_f32 v84, v84
    v_sin_f32 v87, v86
    v_cos_f32 v86, v86
    s_waitcnt vmcnt(8)
    s_mov_b32 s40, 0
F2_loop:
    v_pk_add_f32 v[88:89], v[16:17], v[24:25] neg_lo:[0,1] neg_hi:[0,1]
    v_pk_add_f32 v[16:17], v[16:17], v[24:25]
    v_pk_add_f32 v[90:91], v[18:19], v[26:27] neg_lo:[0,1] neg_hi:[0,1]
    v_pk_add_f32 v[18:19], v[18:19], v[26:27]
    v_pk_add_f32 v[92:93], v[20:21], v[28:29] neg_lo:[0,1] neg_hi:[0,1]
    v_pk_add_f32 v[20:21], v[20:21], v[28:29]
    v_pk_add_f32 v[94:95], v[22:23], v[30:31] neg_lo:[0,1] neg_hi:[0,1]
    v_pk_add_f32 v[22:23], v[22:23], v[30:31]
    v_pk_add_f32 v[96:97], v[16:17], v[20:21] neg_lo:[0,1] neg_hi:[0,1]
    v_pk_add_f32 v[16:17], v[16:17], v[20:21]
    v_pk_add_f32 v[98:99], v[18:19], v[22:23] neg_lo:[0,1] neg_hi:[0,1]
    v_pk_add_f32 v[18:19], v[18:19], v[22:23]
    v_pk_add_f32 v[100:101], v[16:17], v[18:19] neg_lo:[0,1] neg_hi:[0,1]
    v_pk_add_f32 v[16:17], v[16:17], v[18:19]
    v_add_f32 v102, v96, v99
    v_sub_f32 v103, v97, v98
    v_sub_f32 v96, v96, v99
    v_add_f32 v97, v97, v98
    v_add_f32 v104, v88, v93
    v_sub_f32 v105, v89, v92
    v_sub_f32 v88, v88, v93
    v_add_f32 v89, v89, v92
    v_mov_b32 v15, v90
    v_add_f32 v90, v90, v91
    v_sub_f32 v91, v91, v15
    v_mov_b32 v15, v94
    v_add_f32 v94, -v94, v95
    v_sub_f32 v95, -v95, v15
    v_pk_add_f32 v[106:107], v[90:91], v[94:95] neg_lo:[0,1] neg_hi:[0,1]
    v_pk_add_f32 v[90:91], v[90:91], v[94:95]
    v_pk_fma_f32 v[24:25], v[90:91], s[36:37], v[104:105]
    v_pk_fma_f32 v[104:105], v[90:91], s[36:37], v[104:105] neg_lo:[1,0,0] neg_hi:[1,0,0]
    v_fma_f32 v26, v107, s36, v88
    v_fma_f32 v27, -v106, s36, v89
    v_fma_f32 v88, -v107, s36, v88
    v_fma_f32 v89, v106, s36, v89
    ds_write_b64 v7, v[16:17] offset:0
    ds_write_b64 v7, v[24:25] offset:8
    ds_write_b64 v7, v[102:103] offset:16
    ds_write_b64 v7, v[26:27] offset:24
    ds_write_b64 v7, v[100:101] offset:32
    ds_write_b64 v7, v[104:105] offset:40
    ds_write_b64 v7, v[96:97] offset:48
    ds_write_b64 v7, v[88:89] offset:56
    s_waitcnt lgkmcnt(0)
    s_barrier
    ds_read_b64 v[16:17], v8 offset:0
    ds_read_b64 v[24:25], v8 offset:2304
    ds_read_b64 v[102:103], v8 offset:4608
    ds_read_b64 v[26:27], v8 offset:6912
    ds_read_b64 v[100:101], v8 offset:9216
    ds_read_b64 v[104:105], v8 offset:11520
    ds_read_b64 v[96:97], v8 offset:13824
    ds_read_b64 v[88:89], v8 offset:16128
    s_waitcnt lgkmcnt(0)
    v_mul_f32 v28, v25, v43
    v_mul_f32 v29, v24, v43
    v_fma_f32 v24, v24, v42, -v28
    v_fma_f32 v25, v25, v42, v29
    v_mul_f32 v30, v103, v45
    v_mul_f32 v31, v102, v45
    v_fma_f32 v102, v102, v44, -v30
    v_fma_f32 v103, v103, v44, v31
    v_mul_f32 v20, v27, v47
    v_mul_f32 v21, v26, v47
    v_fma_f32 v26, v26, v46, -v20
    v_fma_f32 v27, v27, v46, v21
    v_mul_f32 v22, v101, v49
    v_mul_f32 v23, v100, v49
    v_fma_f32 v100, v100, v48, -v22
    v_fma_f32 v101, v101, v48, v23
    v_mul_f32 v18, v105, v51
    v_mul_f32 v19, v104, v51
    v_fma_f32 v104, v104, v50, -v18
    v_fma_f32 v105, v105, v50, v19
    v_mul_f32 v98, v97, v53
    v_mul_f32 v99, v96, v53
    v_fma_f32 v96, v96, v52, -v98
    v_fma_f32 v97, v97, v52, v99
    v_mul_f32 v92, v89, v55
    v_mul_f32 v93, v88, v55
    v_fma_f32 v88, v88, v54, -v92
    v_fma_f32 v89, v89, v54, v93
    v_pk_add_f32 v[94:95], v[16:17], v[100:101] neg_lo:[0,1] neg_hi:[0,1]
    v_pk_add_f32 v[16:17], v[16:17], v[100:101]
    v_pk_add_f32 v[90:91], v[24:25], v[104:105] neg_lo:[0,1] neg_hi:[0,1]
    v_pk_add_f32 v[24:25], v[24:25], v[104:105]
    v_pk_add_f32 v[106:107], v[102:103], v[96:97] neg_lo:[0,1] neg_hi:[0,1]
    v_pk_add_f32 v[102:103], v[102:103], v[96:97]
    v_pk_add_f32 v[28:29], v[26:27], v[88:89] neg_lo:[0,1] neg_hi:[0,1]
    v_pk_add_f32 v[26:27], v[26:27], v[88:89]
    v_pk_add_f32 v[30:31], v[16:17], v[102:103] neg_lo:[0,1] neg_hi:[0,1]
    v_pk_add_f32 v[16:17], v[16:17], v[102:103]
    v_pk_add_f32 v[20:21], v[24:25], v[26:27] neg_lo:[0,1] neg_hi:[0,1]
    v_pk_add_f32 v[24:25], v[24:25], v[26:27]
    v_pk_add_f32 v[22:23], v[16:17], v[24:25] neg_lo:[0,1] neg_hi:[0,1]
    v_pk_add_f32 v[16:17], v[16:17], v[24:25]
    v_add_f32 v18, v30, v21
    v_sub_f32 v19, v31, v20
    v_sub_f32 v30, v30, v21
    v_add_f32 v31, v31, v20
    v_add_f32 v98, v94, v107
    v_sub_f32 v99, v95, v106
    v_sub_f32 v94, v94, v107
    v_add_f32 v95, v95, v106
    v_mov_b32 v15, v90
    v_add_f32 v90, v90, v91
    v_sub_f32 v91, v91, v15
    v_mov_b32 v15, v28
    v_add_f32 v28, -v28, v29
    v_sub_f32 v29, -v29, v15
    v_pk_add_f32 v[92:93], v[90:91], v[28:29] neg_lo:[0,1] neg_hi:[0,1]
    v_pk_add_f32 v[90:91], v[90:91], v[28:29]
    v_pk_fma_f32 v[100:101], v[90:91], s[36:37], v[98:99]
    v_pk_fma_f32 v[98:99], v[90:91], s[36:37], v[98:99] neg_lo:[1,0,0] neg_hi:[1,0,0]
    v_fma_f32 v104, v93, s36, v94
    v_fma_f32 v105, -v92, s36, v95
    v_fma_f32 v94, -v93, s36, v94
    v_fma_f32 v95, v92, s36, v95
    ds_write_b64 v9, v[16:17] offset:18432
    ds_write_b64 v9, v[100:101] offset:18504
    ds_write_b64 v9, v[18:19] offset:18576
    ds_write_b64 v9, v[104:105] offset:18648
    ds_write_b64 v9, v[22:23] offset:18720
    ds_write_b64 v9, v[98:99] offset:18792
    ds_write_b64 v9, v[30:31] offset:18864
    ds_write_b64 v9, v[94:95] offset:18936
    s_waitcnt lgkmcnt(0)
    s_barrier
    ds_read_b64 v[16:17], v8 offset:18432
    ds_read_b64 v[100:101], v8 offset:20736
    ds_read_b64 v[18:19], v8 offset:23040
    ds_read_b64 v[104:105], v8 offset:25344
    ds_read_b64 v[22:23], v8 offset:27648
    ds_read_b64 v[98:99], v8 offset:29952
    ds_read_b64 v[30:31], v8 offset:32256
    ds_read_b64 v[94:95], v8 offset:34560
    s_waitcnt lgkmcnt(0)
    v_mul_f32 v96, v101, v59
    v_mul_f32 v97, v100, v59
    v_fma_f32 v100, v100, v58, -v96
    v_fma_f32 v101, v101, v58, v97
    v_mul_f32 v88, v19, v61
    v_mul_f32 v89, v18, v61
    v_fma_f32 v18, v18, v60, -v88
    v_fma_f32 v19, v19, v60, v89
    v_mul_f32 v102, v105, v63
    v_mul_f32 v103, v104, v63
    v_fma_f32 v104, v104, v62, -v102
    v_fma_f32 v105, v105, v62, v103
    v_mul_f32 v26, v23, v65
    v_mul_f32 v27, v22, v65
    v_fma_f32 v22, v22, v64, -v26
    v_fma_f32 v23, v23, v64, v27
    v_mul_f32 v24, v99, v67
    v_mul_f32 v25, v98, v67
    v_fma_f32 v98, v98, v66, -v24
    v_fma_f32 v99, v99, v66, v25
    v_mul_f32 v20, v31, v69
    v_mul_f32 v21, v30, v69
    v_fma_f32 v30, v30, v68, -v20
    v_fma_f32 v31, v31, v68, v21
    v_mul_f32 v106, v95, v71
    v_mul_f32 v107, v94, v71
    v_fma_f32 v94, v94, v70, -v106
    v_fma_f32 v95, v95, v70, v107
    v_pk_add_f32 v[28:29], v[16:17], v[22:23] neg_lo:[0,1] neg_hi:[0,1]
    v_pk_add_f32 v[16:17], v[16:17], v[22:23]
    v_pk_add_f32 v[90:91], v[100:101], v[98:99] neg_lo:[0,1] neg_hi:[0,1]
    v_pk_add_f32 v[100:101], v[100:101], v[98:99]
    v_pk_add_f32 v[92:93], v[18:19], v[30:31] neg_lo:[0,1] neg_hi:[0,1]
    v_pk_add_f32 v[18:19], v[18:19], v[30:31]
    v_pk_add_f32 v[96:97], v[104:105], v[94:95] neg_lo:[0,1] neg_hi:[0,1]
    v_pk_add_f32 v[104:105], v[104:105], v[94:95]
    v_pk_add_f32 v[88:89], v[16:17], v[18:19] neg_lo:[0,1] neg_hi:[0,1]
    v_pk_add_f32 v[16:17], v[16:17], v[18:19]
    v_pk_add_f32 v[102:103], v[100:101], v[104:105] neg_lo:[0,1] neg_hi:[0,1]
    v_pk_add_f32 v[100:101], v[100:101], v[104:105]
    v_pk_add_f32 v[26:27], v[16:17], v[100:101] neg_lo:[0,1] neg_hi:[0,1]
    v_pk_add_f32 v[16:17], v[16:17], v[100:101]
    v_add_f32 v24, v88, v103
    v_sub_f32 v25, v89, v102
    v_sub_f32 v88, v88, v103
    v_add_f32 v89, v89, v102
    v_add_f32 v20, v28, v93
    v_sub_f32 v21, v29, v92
    v_sub_f32 v28, v28, v93
    v_add_f32 v29, v29, v92
    v_mov_b32 v15, v90
    v_add_f32 v90, v90, v91
    v_sub_f32 v91, v91, v15
    v_mov_b32 v15, v96
    v_add_f32 v96, -v96, v97
    v_sub_f32 v97, -v97, v15
    v_pk_add_f32 v[106:107], v[90:91], v[96:97] neg_lo:[0,1] neg_hi:[0,1]
    v_pk_add_f32 v[90:91], v[90:91], v[96:97]
    v_pk_fma_f32 v[22:23], v[90:91], s[36:37], v[20:21]
    v_pk_fma_f32 v[20:21], v[90:91], s[36:37], v[20:21] neg_lo:[1,0,0] neg_hi:[1,0,0]
    v_fma_f32 v98, v107, s36, v28
    v_fma_f32 v99, -v106, s36, v29
    v_fma_f32 v28, -v107, s36, v28
    v_fma_f32 v29, v106, s36, v29
    ds_write_b64 v10, v[16:17] offset:36864
    ds_write_b64 v10, v[22:23] offset:37440
    ds_write_b64 v10, v[24:25] offset:38016
    ds_write_b64 v10, v[98:99] offset:38592
    ds_write_b64 v10, v[26:27] offset:39168
    ds_write_b64 v10, v[20:21] offset:39744
    ds_write_b64 v10, v[88:89] offset:40320
    ds_write_b64 v10, v[28:29] offset:40896
    s_waitcnt lgkmcnt(0)
    s_barrier
    ds_read_b64 v[16:17], v8 offset:36864
    ds_read_b64 v[22:23], v8 offset:39168
    ds_read_b64 v[24:25], v8 offset:41472
    ds_read_b64 v[98:99], v8 offset:43776
    ds_read_b64 v[26:27], v8 offset:46080
    ds_read_b64 v[20:21], v8 offset:48384
    ds_read_b64 v[88:89], v8 offset:50688
    ds_read_b64 v[28:29], v8 offset:52992
    s_waitcnt lgkmcnt(0)
    v_mul_f32 v30, v25, v75
    v_mul_f32 v31, v24, v75
    v_fma_f32 v24, v24, v74, -v30
    v_fma_f32 v25, v25, v74, v31
    v_mul_f32 v94, v99, v83
    v_mul_f32 v95, v98, v83
    v_fma_f32 v98, v98, v82, -v94
    v_fma_f32 v99, v99, v82, v95
    v_mul_f32 v18, v27, v77
    v_mul_f32 v19, v26, v77
    v_fma_f32 v26, v26, v76, -v18
    v_fma_f32 v27, v27, v76, v19
    v_mul_f32 v104, v21, v85
    v_mul_f32 v105, v20, v85
    v_fma_f32 v20, v20, v84, -v104
    v_fma_f32 v21, v21, v84, v105
    v_mul_f32 v100, v89, v79
    v_mul_f32 v101, v88, v79
    v_fma_f32 v88, v88, v78, -v100
    v_fma_f32 v89, v89, v78, v101
    v_mul_f32 v102, v29, v87
    v_mul_f32 v103, v28, v87
    v_fma_f32 v28, v28, v86, -v102
    v_fma_f32 v29, v29, v86, v103
    v_pk_add_f32 v[92:93], v[16:17], v[26:27] neg_lo:[0,1] neg_hi:[0,1]
    v_pk_add_f32 v[16:17], v[16:17], v[26:27]
    v_pk_add_f32 v[96:97], v[24:25], v[88:89] neg_lo:[0,1] neg_hi:[0,1]
    v_pk_add_f32 v[24:25], v[24:25], v[88:89]
    v_pk_add_f32 v[90:91], v[16:17], v[24:25] neg_lo:[0,1] neg_hi:[0,1]
    v_pk_add_f32 v[16:17], v[16:17], v[24:25]
    v_add_f32 v106, v92, v97
    v_sub_f32 v107, v93, v96
    v_sub_f32 v92, v92, v97
    v_add_f32 v93, v93, v96
    v_pk_add_f32 v[30:31], v[22:23], v[20:21] neg_lo:[0,1] neg_hi:[0,1]
    v_pk_add_f32 v[22:23], v[22:23], v[20:21]
    v_pk_add_f32 v[94:95], v[98:99], v[28:29] neg_lo:[0,1] neg_hi:[0,1]
    v_pk_add_f32 v[98:99], v[98:99], v[28:29]
    v_pk_add_f32 v[18:19], v[22:23], v[98:99] neg_lo:[0,1] neg_hi:[0,1]
    v_pk_add_f32 v[22:23], v[22:23], v[98:99]
    v_add_f32 v104, v30, v95
    v_sub_f32 v105, v31, v94
    v_sub_f32 v30, v30, v95
    v_add_f32 v31, v31, v94
    s_cmp_eq_u32 s40, 1
    s_cbranch_scc1 F2_store
    s_waitcnt vmcnt(0)
    s_cmp_eq_u32 s20, 0
    s_cbranch_scc1 F2_col0
    v_lshlrev_b32 v124, 16, v32
    v_and_b32 v125, s32, v32
    v_pk_mul_f32 v[124:125], v[124:125], s[34:35]
    v_mul_f32 v126, v17, v125
    v_mul_f32 v127, v16, v125
    v_fma_f32 v108, v16, v124, -v126
    v_fma_f32 v109, -v17, v124, -v127
    v_lshlrev_b32 v124, 16, v33
    v_and_b32 v125, s32, v33
    v_pk_mul_f32 v[124:125], v[124:125], s[34:35]
    v_mul_f32 v126, v23, v125
    v_mul_f32 v127, v22, v125
    v_fma_f32 v110, v22, v124, -v126
    v_fma_f32 v111, -v23, v124, -v127
    v_lshlrev_b32 v124, 16, v34
    v_and_b32 v125, s32, v34
    v_pk_mul_f32 v[124:125], v[124:125], s[34:35]
    v_mul_f32 v126, v107, v125
    v_mul_f32 v127, v106, v125
    v_fma_f32 v112, v106, v124, -v126
    v_fma_f32 v113, -v107, v124, -v127
    v_lshlrev_b32 v124, 16, v35
    v_and_b32 v125, s32, v35
    v_pk_mul_f32 v[124:125], v[124:125], s[34:35]
    v_mul_f32 v126, v105, v125
    v_mul_f32 v127, v104, v125
    v_fma_f32 v114, v104, v124, -v126
    v_fma_f32 v115, -v105, v124, -v127
    v_lshlrev_b32 v124, 16, v36
    v_and_b32 v125, s32, v36
    v_pk_mul_f32 v[124:125], v[124:125], s[34:35]
    v_mul_f32 v126, v91, v125
    v_mul_f32 v127, v90, v125
    v_fma_f32 v116, v90, v124, -v126
    v_fma_f32 v117, -v91, v124, -v127
    v_lshlrev_b32 v124, 16, v37
    v_and_b32 v125, s32, v37
    v_pk_mul_f32 v[124:125], v[124:125], s[34:35]
    v_mul_f32 v126, v19, v125
    v_mul_f32 v127, v18, v125
    v_fma_f32 v118, v18, v124, -v126
    v_fma_f32 v119, -v19, v124, -v127
    v_lshlrev_b32 v124, 16, v38
    v_and_b32 v125, s32, v38
    v_pk_mul_f32 v[124:125], v[124:125], s[34:35]
    v_mul_f32 v126, v93, v125
    v_mul_f32 v127, v92, v125
    v_fma_f32 v120, v92, v124, -v126
    v_fma_f32 v121, -v93, v124, -v127
    v_lshlrev_b32 v124, 16, v39
    v_and_b32 v125, s32, v39
    v_pk_mul_f32 v[124:125], v[124:125], s[34:35]
    v_mul_f32 v126, v31, v125
    v_mul_f32 v127, v30, v125
    v_fma_f32 v122, v30, v124, -v126
    v_fma_f32 v123, -v31, v124, -v127
F2_mov:
    v_mov_b64 v[16:17], v[108:109]
    v_mov_b64 v[18:19], v[110:111]
    v_mov_b64 v[20:21], v[112:113]
    v_mov_b64 v[22:23], v[114:115]
    v_mov_b64 v[24:25], v[116:117]
    v_mov_b64 v[26:27], v[118:119]
    v_mov_b64 v[28:29], v[120:121]
    v_mov_b64 v[30:31], v[122:123]
    s_mov_b32 s40, 1
    s_branch F2_loop
F2_col0:
    s_add_u32 s52, s10, 25165824
    s_addc_u32 s53, s11, 0
    s_mov_b32 s54, 2105344
    s_mov_b32 s55, 0x00020000
    v_sub_u32 v172, 0, v0
    v_subrev_u32 v173, 0, v172
    v_and_b32 v173, 0x7ff, v173
    v_lshlrev_b32 v174, 2, v173
    buffer_load_dword v132, v174, s[52:55], 0 offen
    s_mov_b32 s41, 2097152
    buffer_load_dword v148, v174, s[52:55], s41 offen
    s_mov_b32 s41, 2097152
    buffer_load_dword v140, v6, s[52:55], s41 offen
    v_lshrrev_b32 v174, 3, v173
    v_add_u32 v174, v174, v173
    v_lshlrev_b32 v176, 3, v174
    v_subrev_u32 v173, 256, v172
    v_and_b32 v173, 0x7ff, v173
    v_lshlrev_b32 v174, 2, v173
    buffer_load_dword v133, v174, s[52:55], 0 offen
    s_mov_b32 s41, 2097152
    buffer_load_dword v149, v174, s[52:55], s41 offen
    s_mov_b32 s41, 2098176
    buffer_load_dword v141, v6, s[52:55], s41 offen
    v_lshrrev_b32 v174, 3, v173
    v_add_u32 v174, v174, v173
    v_lshlrev_b32 v177, 3, v174
    v_subrev_u32 v173, 512, v172
    v_and_b32 v173, 0x7ff, v173
    v_lshlrev_b32 v174, 2, v173
    buffer_load_dword v134, v174, s[52:55], 0 offen
    s_mov_b32 s41, 2097152
    buffer_load_dword v150, v174, s[52:55], s41 offen
    s_mov_b32 s41, 2099200
    buffer_load_dword v142, v6, s[52:55], s41 offen
    v_lshrrev_b32 v174, 3, v173
    v_add_u32 v174, v174, v173
    v_lshlrev_b32 v178, 3, v174
    v_subrev_u32 v173, 768, v172
    v_and_b32 v173, 0x7ff, v173
    v_lshlrev_b32 v174, 2, v173
    buffer_load_dword v135, v174, s[52:55], 0 offen
    s_mov_b32 s41, 2097152
    buffer_load_dword v151, v174, s[52:55], s41 offen
    s_mov_b32 s41, 2100224
    buffer_load_dword v143, v6, s[52:55], s41 offen
    v_lshrrev_b32 v174, 3, v173
    v_add_u32 v174, v174, v173
    v_lshlrev_b32 v179, 3, v174
    v_subrev_u32 v173, 1024, v172
    v_and_b32 v173, 0x7ff, v173
    v_lshlrev_b32 v174, 2, v173
    buffer_load_dword v136, v174, s[52:55], 0 offen
    s_mov_b32 s41, 2097152
    buffer_load_dword v152, v174, s[52:55], s41 offen
    s_mov_b32 s41, 2101248
    buffer_load_dword v144, v6, s[52:55], s41 offen
    v_lshrrev_b32 v174, 3, v173
    v_add_u32 v174, v174, v173
    v_lshlrev_b32 v180, 3, v174
    v_subrev_u32 v173, 1280, v172
    v_and_b32 v173, 0x7ff, v173
    v_lshlrev_b32 v174, 2, v173
    buffer_load_dword v137, v174, s[52:55], 0 offen
    s_mov_b32 s41, 2097152
    buffer_load_dword v153, v174, s[52:55], s41 offen
    s_mov_b32 s41, 2102272
    buffer_load_dword v145, v6, s[52:55], s41 offen
    v_lshrrev_b32 v174, 3, v173
    v_add_u32 v174, v174, v173
    v_lshlrev_b32 v181, 3, v174
    v_subrev_u32 v173, 1536, v172
    v_and_b32 v173, 0x7ff, v173
    v_lshlrev_b32 v174, 2, v173
    buffer_load_dword v138, v174, s[52:55], 0 offen
    s_mov_b32 s41, 2097152
    buffer_load_dword v154, v174, s[52:55], s41 offen
    s_mov_b32 s41, 2103296
    buffer_load_dword v146, v6, s[52:55], s41 offen
    v_lshrrev_b32 v174, 3, v173
    v_add_u32 v174, v174, v173
    v_lshlrev_b32 v182, 3, v174
    v_subrev_u32 v173, 1792, v172
    v_and_b32 v173, 0x7ff, v173
    v_lshlrev_b32 v174, 2, v173
    buffer_load_dword v139, v174, s[52:55], 0 offen
    s_mov_b32 s41, 2097152
    buffer_load_dword v155, v174, s[52:55], s41 offen
    s_mov_b32 s41, 2104320
    buffer_load_dword v147, v6, s[52:55], s41 offen
    v_lshrrev_b32 v174, 3, v173
    v_add_u32 v174, v174, v173
    v_lshlrev_b32 v183, 3, v174
    ds_write_b64 v8, v[16:17] offset:0
    ds_write_b64 v8, v[22:23] offset:2304
    ds_write_b64 v8, v[106:107] offset:4608
    ds_write_b64 v8, v[104:105] offset:6912
    ds_write_b64 v8, v[90:91] offset:9216
    ds_write_b64 v8, v[18:19] offset:11520
    ds_write_b64 v8, v[92:93] offset:13824
    ds_write_b64 v8, v[30:31] offset:16128
    s_waitcnt lgkmcnt(0)
    s_barrier
    ds_read_b64 v[156:157], v176
    ds_read_b64 v[158:159], v177
    ds_read_b64 v[160:161], v178
    ds_read_b64 v[162:163], v179
    ds_read_b64 v[164:165], v180
    ds_read_b64 v[166:167], v181
    ds_read_b64 v[168:169], v182
    ds_read_b64 v[170:171], v183
    s_waitcnt vmcnt(0) lgkmcnt(0)
    s_barrier
    s_mov_b32 s41, 872415232
    v_add_f32 v184, v16, v156
    v_sub_f32 v185, v17, v157
    v_add_f32 v186, v17, v157
    v_sub_f32 v187, v156, v16
    v_lshlrev_b32 v188, 16, v32
    v_and_b32 v189, s32, v32
    v_lshlrev_b32 v192, 16, v132
    v_and_b32 v193, s32, v132
    v_add_f32 v188, v188, v192
    v_sub_f32 v189, v189, v193
    v_lshlrev_b32 v190, 16, v140
    v_and_b32 v191, s32, v140
    v_lshlrev_b32 v192, 16, v148
    v_and_b32 v193, s32, v148
    v_add_f32 v190, v190, v192
    v_sub_f32 v191, v191, v193
    v_mul_f32 v192, v184, v188
    v_fma_f32 v192, -v185, v189, v192
    v_fma_f32 v192, -v186, v191, v192
    v_fma_f32 v192, -v187, v190, v192
    v_mul_f32 v193, v184, v189
    v_fma_f32 v193, v185, v188, v193
    v_fma_f32 v193, v186, v190, v193
    v_fma_f32 v193, -v187, v191, v193
    v_mul_f32 v108, s41, v192
    v_mul_f32 v109, s41, v193
    v_sub_f32 v109, 0, v109
    v_add_f32 v184, v22, v158
    v_sub_f32 v185, v23, v159
    v_add_f32 v186, v23, v159
    v_sub_f32 v187, v158, v22
    v_lshlrev_b32 v188, 16, v33
    v_and_b32 v189, s32, v33
    v_lshlrev_b32 v192, 16, v133
    v_and_b32 v193, s32, v133
    v_add_f32 v188, v188, v192
    v_sub_f32 v189, v189, v193
    v_lshlrev_b32 v190, 16, v141
    v_and_b32 v191, s32, v141
    v_lshlrev_b32 v192, 16, v149
    v_and_b32 v193, s32, v149
    v_add_f32 v190, v190, v192
    v_sub_f32 v191, v191, v193
    v_mul_f32 v192, v184, v188
    v_fma_f32 v192, -v185, v189, v192
    v_fma_f32 v192, -v186, v191, v192
    v_fma_f32 v192, -v187, v190, v192
    v_mul_f32 v193, v184, v189
    v_fma_f32 v193, v185, v188, v193
    v_fma_f32 v193, v186, v190, v193
    v_fma_f32 v193, -v187, v191, v193
    v_mul_f32 v110, s41, v192
    v_mul_f32 v111, s41, v193
    v_sub_f32 v111, 0, v111
    v_add_f32 v184, v106, v160
    v_sub_f32 v185, v107, v161
    v_add_f32 v186, v107, v161
    v_sub_f32 v187, v160, v106
    v_lshlrev_b32 v188, 16, v34
    v_and_b32 v189, s32, v34
    v_lshlrev_b32 v192, 16, v134
    v_and_b32 v193, s32, v134
    v_add_f32 v188, v188, v192
    v_sub_f32 v189, v189, v193
    v_lshlrev_b32 v190, 16, v142
    v_and_b32 v191, s32, v142
    v_lshlrev_b32 v192, 16, v150
    v_and_b32 v193, s32, v150
    v_add_f32 v190, v190, v192
    v_sub_f32 v191, v191, v193
    v_mul_f32 v192, v184, v188
    v_fma_f32 v192, -v185, v189, v192
    v_fma_f32 v192, -v186, v191, v192
    v_fma_f32 v192, -v187, v190, v192
    v_mul_f32 v193, v184, v189
    v_fma_f32 v193, v185, v188, v193
    v_fma_f32 v193, v186, v190, v193
    v_fma_f32 v193, -v187, v191, v193
    v_mul_f32 v112, s41, v192
    v_mul_f32 v113, s41, v193
    v_sub_f32 v113, 0, v113
    v_add_f32 v184, v104, v162
    v_sub_f32 v185, v105, v163
    v_add_f32 v186, v105, v163
    v_sub_f32 v187, v162, v104
    v_lshlrev_b32 v188, 16, v35
    v_and_b32 v189, s32, v35
    v_lshlrev_b32 v192, 16, v135
    v_and_b32 v193, s32, v135
    v_add_f32 v188, v188, v192
    v_sub_f32 v189, v189, v193
    v_lshlrev_b32 v190, 16, v143
    v_and_b32 v191, s32, v143
    v_lshlrev_b32 v192, 16, v151
    v_and_b32 v193, s32, v151
    v_add_f32 v190, v190, v192
    v_sub_f32 v191, v191, v193
    v_mul_f32 v192, v184, v188
    v_fma_f32 v192, -v185, v189, v192
    v_fma_f32 v192, -v186, v191, v192
    v_fma_f32 v192, -v187, v190, v192
    v_mul_f32 v193, v184, v189
    v_fma_f32 v193, v185, v188, v193
    v_fma_f32 v193, v186, v190, v193
    v_fma_f32 v193, -v187, v191, v193
    v_mul_f32 v114, s41, v192
    v_mul_f32 v115, s41, v193
    v_sub_f32 v115, 0, v115
    v_add_f32 v184, v90, v164
    v_sub_f32 v185, v91, v165
    v_add_f32 v186, v91, v165
    v_sub_f32 v187, v164, v90
    v_lshlrev_b32 v188, 16, v36
    v_and_b32 v189, s32, v36
    v_lshlrev_b32 v192, 16, v136
    v_and_b32 v193, s32, v136
    v_add_f32 v188, v188, v192
    v_sub_f32 v189, v189, v193
    v_lshlrev_b32 v190, 16, v144
    v_and_b32 v191, s32, v144
    v_lshlrev_b32 v192, 16, v152
    v_and_b32 v193, s32, v152
    v_add_f32 v190, v190, v192
    v_sub_f32 v191, v191, v193
    v_mul_f32 v192, v184, v188
    v_fma_f32 v192, -v185, v189, v192
    v_fma_f32 v192, -v186, v191, v192
    v_fma_f32 v192, -v187, v190, v192
    v_mul_f32 v193, v184, v189
    v_fma_f32 v193, v185, v188, v193
    v_fma_f32 v193, v186, v190, v193
    v_fma_f32 v193, -v187, v191, v193
    v_mul_f32 v116, s41, v192
    v_mul_f32 v117, s41, v193
    v_sub_f32 v117, 0, v117
    v_add_f32 v184, v18, v166
    v_sub_f32 v185, v19, v167
    v_add_f32 v186, v19, v167
    v_sub_f32 v187, v166, v18
    v_lshlrev_b32 v188, 16, v37
    v_and_b32 v189, s32, v37
    v_lshlrev_b32 v192, 16, v137
    v_and_b32 v193, s32, v137
    v_add_f32 v188, v188, v192
    v_sub_f32 v189, v189, v193
    v_lshlrev_b32 v190, 16, v145
    v_and_b32 v191, s32, v145
    v_lshlrev_b32 v192, 16, v153
    v_and_b32 v193, s32, v153
    v_add_f32 v190, v190, v192
    v_sub_f32 v191, v191, v193
    v_mul_f32 v192, v184, v188
    v_fma_f32 v192, -v185, v189, v192
    v_fma_f32 v192, -v186, v191, v192
    v_fma_f32 v192, -v187, v190, v192
    v_mul_f32 v193, v184, v189
    v_fma_f32 v193, v185, v188, v193
    v_fma_f32 v193, v186, v190, v193
    v_fma_f32 v193, -v187, v191, v193
    v_mul_f32 v118, s41, v192
    v_mul_f32 v119, s41, v193
    v_sub_f32 v119, 0, v119
    v_add_f32 v184, v92, v168
    v_sub_f32 v185, v93, v169
    v_add_f32 v186, v93, v169
    v_sub_f32 v187, v168, v92
    v_lshlrev_b32 v188, 16, v38
    v_and_b32 v189, s32, v38
    v_lshlrev_b32 v192, 16, v138
    v_and_b32 v193, s32, v138
    v_add_f32 v188, v188, v192
    v_sub_f32 v189, v189, v193
    v_lshlrev_b32 v190, 16, v146
    v_and_b32 v191, s32, v146
    v_lshlrev_b32 v192, 16, v154
    v_and_b32 v193, s32, v154
    v_add_f32 v190, v190, v192
    v_sub_f32 v191, v191, v193
    v_mul_f32 v192, v184, v188
    v_fma_f32 v192, -v185, v189, v192
    v_fma_f32 v192, -v186, v191, v192
    v_fma_f32 v192, -v187, v190, v192
    v_mul_f32 v193, v184, v189
    v_fma_f32 v193, v185, v188, v193
    v_fma_f32 v193, v186, v190, v193
    v_fma_f32 v193, -v187, v191, v193
    v_mul_f32 v120, s41, v192
    v_mul_f32 v121, s41, v193
    v_sub_f32 v121, 0, v121
    v_add_f32 v184, v30, v170
    v_sub_f32 v185, v31, v171
    v_add_f32 v186, v31, v171
    v_sub_f32 v187, v170, v30
    v_lshlrev_b32 v188, 16, v39
    v_and_b32 v189, s32, v39
    v_lshlrev_b32 v192, 16, v139
    v_and_b32 v193, s32, v139
    v_add_f32 v188, v188, v192
    v_sub_f32 v189, v189, v193
    v_lshlrev_b32 v190, 16, v147
    v_and_b32 v191, s32, v147
    v_lshlrev_b32 v192, 16, v155
    v_and_b32 v193, s32, v155
    v_add_f32 v190, v190, v192
    v_sub_f32 v191, v191, v193
    v_mul_f32 v192, v184, v188
    v_fma_f32 v192, -v185, v189, v192
    v_fma_f32 v192, -v186, v191, v192
    v_fma_f32 v192, -v187, v190, v192
    v_mul_f32 v193, v184, v189
    v_fma_f32 v193, v185, v188, v193
    v_fma_f32 v193, v186, v190, v193
    v_fma_f32 v193, -v187, v191, v193
    v_mul_f32 v122, s41, v192
    v_mul_f32 v123, s41, v193
    v_sub_f32 v123, 0, v123
    s_branch F2_mov
F2_store:
    buffer_store_dwordx2 v[16:17], v5, s[16:19], 0 offen offset:0
    buffer_store_dwordx2 v[22:23], v5, s[16:19], 0 offen offset:2048
    buffer_store_dwordx2 v[106:107], v5, s[16:19], s48 offen offset:0
    buffer_store_dwordx2 v[104:105], v5, s[16:19], s48 offen offset:2048
    buffer_store_dwordx2 v[90:91], v5, s[16:19], s49 offen offset:0
    buffer_store_dwordx2 v[18:19], v5, s[16:19], s49 offen offset:2048
    buffer_store_dwordx2 v[92:93], v5, s[16:19], s50 offen offset:0
    buffer_store_dwordx2 v[30:31], v5, s[16:19], s50 offen offset:2048
    s_waitcnt vmcnt(0)
    s_endpgm
K2_end:
    s_endpgm
.globl gm_k3_kernel
.p2align 8
.type gm_k3_kernel,@function
gm_k3_kernel:
    s_cmp_ge_u32 s2, 256
    s_cbranch_scc1 K3_end
    s_getpc_b64 s[90:91]
    v_lshlrev_b32 v116, 7, v0
    v_min_u32 v116, K3_end-gm_k3_kernel-16, v116
    global_load_dword v116, v116, s[90:91]
    s_load_dwordx2 s[10:11], s[0:1], 80
    s_load_dwordx2 s[4:5], s[0:1], 64
    s_lshl_b32 s20, s2, 3
    v_lshrrev_b32 v2, 6, v0
    v_and_b32 v1, 63, v0
    v_readfirstlane_b32 s26, v2
    s_waitcnt lgkmcnt(0)
    s_add_u32 s12, s10, 16777216
    s_addc_u32 s13, s11, 0
    s_mov_b32 s14, 4210688
    s_mov_b32 s15, 0x00020000
    s_add_u32 s16, s10, 29360128
    s_addc_u32 s17, s11, 0
    s_mov_b32 s18, 2097152
    s_mov_b32 s19, 0x00020000
    s_mov_b32 s44, s4
    s_mov_b32 s45, s5
    s_mov_b32 s46, 2097152
    s_mov_b32 s47, 0x00020000
    s_lshl_b32 s27, s26, 1
    s_add_u32 s27, s27, s20
    s_lshl_b32 s28, s27, 2
    s_add_u32 s28, s28, 33554432
    s_load_dwordx2 s[48:49], s[10:11], s28
    s_mov_b32 s36, 1060439283
    s_mov_b32 s37, 1060439283
    s_mov_b32 s32, 0xffff0000
    v_and_b32 v2, 3, v0
    v_lshrrev_b32 v3, 2, v0
    v_lshlrev_b32 v8, 14, v3
    v_lshl_add_u32 v8, v2, 4, v8
    s_lshl_b32 s29, s20, 3
    v_add_u32 v8, s29, v8
    s_mov_b32 s41, 0
    buffer_load_dwordx4 v[16:19], v8, s[12:15], s41 offen
    s_mov_b32 s41, 1048576
    buffer_load_dwordx4 v[20:23], v8, s[12:15], s41 offen
    s_mov_b32 s41, 2097152
    buffer_load_dwordx4 v[24:27], v8, s[12:15], s41 offen
    s_mov_b32 s41, 3145728
    buffer_load_dwordx4 v[28:31], v8, s[12:15], s41 offen
    s_lshl_b32 s28, s27, 10
    v_lshlrev_b32 v11, 1, v1
    v_add_u32 v11, s28, v11
    buffer_load_ushort v36, v11, s[16:19], 0 offen offset:0
    buffer_load_ushort v37, v11, s[16:19], 0 offen offset:1024
    buffer_load_ushort v38, v11, s[16:19], 0 offen offset:128
    buffer_load_ushort v39, v11, s[16:19], 0 offen offset:1152
    buffer_load_ushort v40, v11, s[16:19], 0 offen offset:256
    buffer_load_ushort v41, v11, s[16:19], 0 offen offset:1280
    buffer_load_ushort v42, v11, s[16:19], 0 offen offset:384
    buffer_load_ushort v43, v11, s[16:19], 0 offen offset:1408
    buffer_load_ushort v44, v11, s[16:19], 0 offen offset:512
    buffer_load_ushort v45, v11, s[16:19], 0 offen offset:1536
    buffer_load_ushort v46, v11, s[16:19], 0 offen offset:640
    buffer_load_ushort v47, v11, s[16:19], 0 offen offset:1664
    buffer_load_ushort v48, v11, s[16:19], 0 offen offset:768
    buffer_load_ushort v49, v11, s[16:19], 0 offen offset:1792
    buffer_load_ushort v50, v11, s[16:19], 0 offen offset:896
    buffer_load_ushort v51, v11, s[16:19], 0 offen offset:1920
    v_mul_u32_u24 v4, 4672, v2
    v_lshrrev_b32 v9, 3, v3
    v_add_u32 v9, v9, v3
    v_lshl_add_u32 v9, v9, 3, v4
    v_sub_u32 v10, 64, v3
    v_lshrrev_b32 v3, 3, v10
    v_add_u32 v10, v10, v3
    v_lshl_add_u32 v10, v10, 3, v4
    v_add_u32 v12, 2304, v4
    s_mul_i32 s40, s26, 4672
    v_mul_u32_u24 v5, 72, v1
    v_add_u32 v5, s40, v5
    v_lshrrev_b32 v2, 3, v1
    v_add_u32 v6, v2, v1
    v_lshlrev_b32 v6, 3, v6
    v_add_u32 v6, s40, v6
    v_mul_u32_u24 v7, 576, v2
    v_and_b32 v2, 7, v1
    v_lshl_add_u32 v7, v2, 3, v7
    v_add_u32 v7, s40, v7
    v_and_b32 v2, 7, v1
    v_cvt_f32_u32 v3, v2
    v_mul_f32 v66, 0xbc800000, v3
    v_mul_f32 v68, 0xbd000000, v3
    v_mul_f32 v70, 0xbd400000, v3
    v_mul_f32 v72, 0xbd800000, v3
    v_mul_f32 v74, 0xbda00000, v3
    v_mul_f32 v76, 0xbdc00000, v3
    v_mul_f32 v78, 0xbde00000, v3
    v_sin_f32 v67, v66
    v_cos_f32 v66, v66
    v_sin_f32 v69, v68
    v_cos_f32 v68, v68
    v_sin_f32 v71, v70
    v_cos_f32 v70, v70
    v_sin_f32 v73, v72
    v_cos_f32 v72, v72
    v_sin_f32 v75, v74
    v_cos_f32 v74, v74
    v_sin_f32 v77, v76
    v_cos_f32 v76, v76
    v_sin_f32 v79, v78
    v_cos_f32 v78, v78
    v_cvt_f32_u32 v3, v1
    v_mul_f32 v82, 0xbb000000, v3
    v_mul_f32 v84, 0xbb800000, v3
    v_mul_f32 v86, 0xbbc00000, v3
    v_mul_f32 v88, 0xbc000000, v3
    v_mul_f32 v90, 0xbc200000, v3
    v_mul_f32 v92, 0xbc400000, v3
    v_mul_f32 v94, 0xbc600000, v3
    v_sin_f32 v83, v82
    v_cos_f32 v82, v82
    v_sin_f32 v85, v84
    v_cos_f32 v84, v84
    v_sin_f32 v87, v86
    v_cos_f32 v86, v86
    v_sin_f32 v89, v88
    v_cos_f32 v88, v88
    v_sin_f32 v91, v90
    v_cos_f32 v90, v90
    v_sin_f32 v93, v92
    v_cos_f32 v92, v92
    v_sin_f32 v95, v94
    v_cos_f32 v94, v94
    s_waitcnt vmcnt(16)
    v_cmp_gt_u32 vcc, 4, v0
    v_mov_b32 v2, 0
    v_sub_f32 v32, 0, v17
    v_sub_f32 v33, 0, v19
    v_cndmask_b32 v17, v17, v2, vcc
    v_cndmask_b32 v19, v19, v2, vcc
    v_pk_add_f32 v[96:97], v[16:17], v[18:19] op_sel:[0,1] op_sel_hi:[1,0] neg_hi:[1,0]
    v_pk_add_f32 v[98:99], v[16:17], v[18:19] op_sel:[0,1] op_sel_hi:[1,0] neg_lo:[0,1]
    ds_write_b64 v9, v[96:97] offset:0
    ds_write_b64 v10, v[98:99] offset:4032
    v_pk_add_f32 v[100:101], v[20:21], v[22:23] op_sel:[0,1] op_sel_hi:[1,0] neg_hi:[1,0]
    v_pk_add_f32 v[102:103], v[20:21], v[22:23] op_sel:[0,1] op_sel_hi:[1,0] neg_lo:[0,1]
    ds_write_b64 v9, v[100:101] offset:576
    ds_write_b64 v10, v[102:103] offset:3456
    v_pk_add_f32 v[104:105], v[24:25], v[26:27] op_sel:[0,1] op_sel_hi:[1,0] neg_hi:[1,0]
    v_pk_add_f32 v[106:107], v[24:25], v[26:27] op_sel:[0,1] op_sel_hi:[1,0] neg_lo:[0,1]
    ds_write_b64 v9, v[104:105] offset:1152
    ds_write_b64 v10, v[106:107] offset:2880
    v_pk_add_f32 v[108:109], v[28:29], v[30:31] op_sel:[0,1] op_sel_hi:[1,0] neg_hi:[1,0]
    v_pk_add_f32 v[110:111], v[28:29], v[30:31] op_sel:[0,1] op_sel_hi:[1,0] neg_lo:[0,1]
    ds_write_b64 v9, v[108:109] offset:1728
    ds_write_b64 v10, v[110:111] offset:2304
    s_and_saveexec_b64 s[38:39], vcc
    ds_write_b64 v12, v[32:33]
    s_mov_b64 exec, s[38:39]
    s_waitcnt lgkmcnt(0)
    s_barrier
    ds_read_b64 v[16:17], v6 offset:0
    ds_read_b64 v[18:19], v6 offset:576
    ds_read_b64 v[20:21], v6 offset:1152
    ds_read_b64 v[22:23], v6 offset:1728
    ds_read_b64 v[24:25], v6 offset:2304
    ds_read_b64 v[26:27], v6 offset:2880
    ds_read_b64 v[28:29], v6 offset:3456
    ds_read_b64 v[30:31], v6 offset:4032
    s_waitcnt lgkmcnt(0)
    v_pk_add_f32 v[112:113], v[16:17], v[24:25] neg_lo:[0,1] neg_hi:[0,1]
    v_pk_add_f32 v[16:17], v[16:17], v[24:25]
    v_pk_add_f32 v[114:115], v[18:19], v[26:27] neg_lo:[0,1] neg_hi:[0,1]
    v_pk_add_f32 v[18:19], v[18:19], v[26:27]
    v_pk_add_f32 v[96:97], v[20:21], v[28:29] neg_lo:[0,1] neg_hi:[0,1]
    v_pk_add_f32 v[20:21], v[20:21], v[28:29]
    v_pk_add_f32 v[98:99], v[22:23], v[30:31] neg_lo:[0,1] neg_hi:[0,1]
    v_pk_add_f32 v[22:23], v[22:23], v[30:31]
    v_pk_add_f32 v[100:101], v[16:17], v[20:21] neg_lo:[0,1] neg_hi:[0,1]
    v_pk_add_f32 v[16:17], v[16:17], v[20:21]
    v_pk_add_f32 v[102:103], v[18:19], v[22:23] neg_lo:[0,1] neg_hi:[0,1]
    v_pk_add_f32 v[18:19], v[18:19], v[22:23]
    v_pk_add_f32 v[104:105], v[16:17], v[18:19] neg_lo:[0,1] neg_hi:[0,1]
    v_pk_add_f32 v[16:17], v[16:17], v[18:19]
    v_pk_add_f32 v[106:107], v[100:101], v[102:103] op_sel:[0,1] op_sel_hi:[1,0] neg_lo:[0,1] neg_hi:[0,0]
    v_pk_add_f32 v[100:101], v[100:101], v[102:103] op_sel:[0,1] op_sel_hi:[1,0] neg_lo:[0,0] neg_hi:[0,1]
    v_pk_add_f32 v[108:109], v[112:113], v[96:97] op_sel:[0,1] op_sel_hi:[1,0] neg_lo:[0,1] neg_hi:[0,0]
    v_pk_add_f32 v[112:113], v[112:113], v[96:97] op_sel:[0,1] op_sel_hi:[1,0] neg_lo:[0,0] neg_hi:[0,1]
    v_pk_add_f32 v[114:115], v[114:115], v[114:115] op_sel:[0,1] op_sel_hi:[1,0] neg_lo:[0,1] neg_hi:[0,0]
    v_pk_add_f32 v[98:99], v[98:99], v[98:99] op_sel:[0,1] op_sel_hi:[1,0] neg_lo:[1,1] neg_hi:[1,0]
    v_pk_add_f32 v[110:111], v[114:115], v[98:99] neg_lo:[0,1] neg_hi:[0,1]
    v_pk_add_f32 v[114:115], v[114:115], v[98:99]
    v_pk_fma_f32 v[24:25], v[114:115], s[36:37], v[108:109]
    v_pk_fma_f32 v[108:109], v[114:115], s[36:37], v[108:109] neg_lo:[1,0,0] neg_hi:[1,0,0]
    v_pk_fma_f32 v[26:27], v[110:111], s[36:37], v[112:113] op_sel:[1,0,0] op_sel_hi:[0,1,1] neg_lo:[1,0,0]
    v_pk_fma_f32 v[112:113], v[110:111], s[36:37], v[112:113] op_sel:[1,0,0] op_sel_hi:[0,1,1] neg_hi:[1,0,0]
    ds_write_b64 v5, v[16:17] offset:0
    ds_write_b64 v5, v[24:25] offset:8
    ds_write_b64 v5, v[106:107] offset:16
    ds_write_b64 v5, v[26:27] offset:24
    ds_write_b64 v5, v[104:105] offset:32
    ds_write_b64 v5, v[108:109] offset:40
    ds_write_b64 v5, v[100:101] offset:48
    ds_write_b64 v5, v[112:113] offset:56
    ds_read_b64 v[16:17], v6 offset:0
    ds_read_b64 v[24:25], v6 offset:576
    ds_read_b64 v[106:107], v6 offset:1152
    ds_read_b64 v[26:27], v6 offset:1728
    ds_read_b64 v[104:105], v6 offset:2304
    ds_read_b64 v[108:109], v6 offset:2880
    ds_read_b64 v[100:101], v6 offset:3456
    ds_read_b64 v[112:113], v6 offset:4032
    s_waitcnt lgkmcnt(0)
    v_pk_mul_f32 v[28:29], v[24:25], v[66:67] op_sel:[0,0] op_sel_hi:[0,1] neg_hi:[0,1]
    v_pk_fma_f32 v[24:25], v[24:25], v[66:67], v[28:29] op_sel:[1,1,0] op_sel_hi:[1,0,1]
    v_pk_mul_f32 v[30:31], v[106:107], v[68:69] op_sel:[0,0] op_sel_hi:[0,1] neg_hi:[0,1]
    v_pk_fma_f32 v[106:107], v[106:107], v[68:69], v[30:31] op_sel:[1,1,0] op_sel_hi:[1,0,1]
    v_pk_mul_f32 v[20:21], v[26:27], v[70:71] op_sel:[0,0] op_sel_hi:[0,1] neg_hi:[0,1]
    v_pk_fma_f32 v[26:27], v[26:27], v[70:71], v[20:21] op_sel:[1,1,0] op_sel_hi:[1,0,1]
    v_pk_mul_f32 v[22:23], v[104:105], v[72:73] op_sel:[0,0] op_sel_hi:[0,1] neg_hi:[0,1]
    v_pk_fma_f32 v[104:105], v[104:105], v[72:73], v[22:23] op_sel:[1,1,0] op_sel_hi:[1,0,1]
    v_pk_mul_f32 v[18:19], v[108:109], v[74:75] op_sel:[0,0] op_sel_hi:[0,1] neg_hi:[0,1]
    v_pk_fma_f32 v[108:109], v[108:109], v[74:75], v[18:19] op_sel:[1,1,0] op_sel_hi:[1,0,1]
    v_pk_mul_f32 v[102:103], v[100:101], v[76:77] op_sel:[0,0] op_sel_hi:[0,1] neg_hi:[0,1]
    v_pk_fma_f32 v[100:101], v[100:101], v[76:77], v[102:103] op_sel:[1,1,0] op_sel_hi:[1,0,1]
    v_pk_mul_f32 v[96:97], v[112:113], v[78:79] op_sel:[0,0] op_sel_hi:[0,1] neg_hi:[0,1]
    v_pk_fma_f32 v[112:113], v[112:113], v[78:79], v[96:97] op_sel:[1,1,0] op_sel_hi:[1,0,1]
    v_pk_add_f32 v[98:99], v[16:17], v[104:105] neg_lo:[0,1] neg_hi:[0,1]
    v_pk_add_f32 v[16:17], v[16:17], v[104:105]
    v_pk_add_f32 v[114:115], v[24:25], v[108:109] neg_lo:[0,1] neg_hi:[0,1]
    v_pk_add_f32 v[24:25], v[24:25], v[108:109]
    v_pk_add_f32 v[110:111], v[106:107], v[100:101] neg_lo:[0,1] neg_hi:[0,1]
    v_pk_add_f32 v[106:107], v[106:107], v[100:101]
    v_pk_add_f32 v[28:29], v[26:27], v[112:113] neg_lo:[0,1] neg_hi:[0,1]
    v_pk_add_f32 v[26:27], v[26:27], v[112:113]
    v_pk_add_f32 v[30:31], v[16:17], v[106:107] neg_lo:[0,1] neg_hi:[0,1]
    v_pk_add_f32 v[16:17], v[16:17], v[106:107]
    v_pk_add_f32 v[20:21], v[24:25], v[26:27] neg_lo:[0,1] neg_hi:[0,1]
    v_pk_add_f32 v[24:25], v[24:25], v[26:27]
    v_pk_add_f32 v[22:23], v[16:17], v[24:25] neg_lo:[0,1] neg_hi:[0,1]
    v_pk_add_f32 v[16:17], v[16:17], v[24:25]
    v_pk_add_f32 v[18:19], v[30:31], v[20:21] op_sel:[0,1] op_sel_hi:[1,0] neg_lo:[0,1] neg_hi:[0,0]
    v_pk_add_f32 v[30:31], v[30:31], v[20:21] op_sel:[0,1] op_sel_hi:[1,0] neg_lo:[0,0] neg_hi:[0,1]
    v_pk_add_f32 v[102:103], v[98:99], v[110:111] op_sel:[0,1] op_sel_hi:[1,0] neg_lo:[0,1] neg_hi:[0,0]
    v_pk_add_f32 v[98:99], v[98:99], v[110:111] op_sel:[0,1] op_sel_hi:[1,0] neg_lo:[0,0] neg_hi:[0,1]
    v_pk_add_f32 v[114:115], v[114:115], v[114:115] op_sel:[0,1] op_sel_hi:[1,0] neg_lo:[0,1] neg_hi:[0,0]
    v_pk_add_f32 v[28:29], v[28:29], v[28:29] op_sel:[0,1] op_sel_hi:[1,0] neg_lo:[1,1] neg_hi:[1,0]
    v_pk_add_f32 v[96:97], v[114:115], v[28:29] neg_lo:[0,1] neg_hi:[0,1]
    v_pk_add_f32 v[114:115], v[114:115], v[28:29]
    v_pk_fma_f32 v[104:105], v[114:115], s[36:37], v[102:103]
    v_pk_fma_f32 v[102:103], v[114:115], s[36:37], v[102:103] neg_lo:[1,0,0] neg_hi:[1,0,0]
    v_pk_fma_f32 v[108:109], v[96:97], s[36:37], v[98:99] op_sel:[1,0,0] op_sel_hi:[0,1,1] neg_lo:[1,0,0]
    v_pk_fma_f32 v[98:99], v[96:97], s[36:37], v[98:99] op_sel:[1,0,0] op_sel_hi:[0,1,1] neg_hi:[1,0,0]
    ds_write_b64 v7, v[16:17] offset:0
    ds_write_b64 v7, v[104:105] offset:72
    ds_write_b64 v7, v[18:19] offset:144
    ds_write_b64 v7, v[108:109] offset:216
    ds_write_b64 v7, v[22:23] offset:288
    ds_write_b64 v7, v[102:103] offset:360
    ds_write_b64 v7, v[30:31] offset:432
    ds_write_b64 v7, v[98:99] offset:504
    ds_read_b64 v[16:17], v6 offset:0
    ds_read_b64 v[104:105], v6 offset:576
    ds_read_b64 v[18:19], v6 offset:1152
    ds_read_b64 v[108:109], v6 offset:1728
    ds_read_b64 v[22:23], v6 offset:2304
    ds_read_b64 v[102:103], v6 offset:2880
    ds_read_b64 v[30:31], v6 offset:3456
    ds_read_b64 v[98:99], v6 offset:4032
    s_waitcnt lgkmcnt(0)
    v_pk_mul_f32 v[100:101], v[104:105], v[82:83] op_sel:[0,0] op_sel_hi:[0,1] neg_hi:[0,1]
    v_pk_fma_f32 v[104:105], v[104:105], v[82:83], v[100:101] op_sel:[1,1,0] op_sel_hi:[1,0,1]
    v_pk_mul_f32 v[112:113], v[18:19], v[84:85] op_sel:[0,0] op_sel_hi:[0,1] neg_hi:[0,1]
    v_pk_fma_f32 v[18:19], v[18:19], v[84:85], v[112:113] op_sel:[1,1,0] op_sel_hi:[1,0,1]
    v_pk_mul_f32 v[106:107], v[108:109], v[86:87] op_sel:[0,0] op_sel_hi:[0,1] neg_hi:[0,1]
    v_pk_fma_f32 v[108:109], v[108:109], v[86:87], v[106:107] op_sel:[1,1,0] op_sel_hi:[1,0,1]
    v_pk_mul_f32 v[26:27], v[22:23], v[88:89] op_sel:[0,0] op_sel_hi:[0,1] neg_hi:[0,1]
    v_pk_fma_f32 v[22:23], v[22:23], v[88:89], v[26:27] op_sel:[1,1,0] op_sel_hi:[1,0,1]
    v_pk_mul_f32 v[24:25], v[102:103], v[90:91] op_sel:[0,0] op_sel_hi:[0,1] neg_hi:[0,1]
    v_pk_fma_f32 v[102:103], v[102:103], v[90:91], v[24:25] op_sel:[1,1,0] op_sel_hi:[1,0,1]
    v_pk_mul_f32 v[20:21], v[30:31], v[92:93] op_sel:[0,0] op_sel_hi:[0,1] neg_hi:[0,1]
    v_pk_fma_f32 v[30:31], v[30:31], v[92:93], v[20:21] op_sel:[1,1,0] op_sel_hi:[1,0,1]
    v_pk_mul_f32 v[110:111], v[98:99], v[94:95] op_sel:[0,0] op_sel_hi:[0,1] neg_hi:[0,1]
    v_pk_fma_f32 v[98:99], v[98:99], v[94:95], v[110:111] op_sel:[1,1,0] op_sel_hi:[1,0,1]
    v_pk_add_f32 v[28:29], v[16:17], v[22:23] neg_lo:[0,1] neg_hi:[0,1]
    v_pk_add_f32 v[16:17], v[16:17], v[22:23]
    v_pk_add_f32 v[114:115], v[104:105], v[102:103] neg_lo:[0,1] neg_hi:[0,1]
    v_pk_add_f32 v[104:105], v[104:105], v[102:103]
    v_pk_add_f32 v[96:97], v[18:19], v[30:31] neg_lo:[0,1] neg_hi:[0,1]
    v_pk_add_f32 v[18:19], v[18:19], v[30:31]
    v_pk_add_f32 v[100:101], v[108:109], v[98:99] neg_lo:[0,1] neg_hi:[0,1]
    v_pk_add_f32 v[108:109], v[108:109], v[98:99]
    v_pk_add_f32 v[112:113], v[16:17], v[18:19] neg_lo:[0,1] neg_hi:[0,1]
    v_pk_add_f32 v[16:17], v[16:17], v[18:19]
    v_pk_add_f32 v[106:107], v[104:105], v[108:109] neg_lo:[0,1] neg_hi:[0,1]
    v_pk_add_f32 v[104:105], v[104:105], v[108:109]
    v_pk_add_f32 v[26:27], v[16:17], v[104:105] neg_lo:[0,1] neg_hi:[0,1]
    v_pk_add_f32 v[16:17], v[16:17], v[104:105]
    v_pk_add_f32 v[24:25], v[112:113], v[106:107] op_sel:[0,1] op_sel_hi:[1,0] neg_lo:[0,1] neg_hi:[0,0]
    v_pk_add_f32 v[112:113], v[112:113], v[106:107] op_sel:[0,1] op_sel_hi:[1,0] neg_lo:[0,0] neg_hi:[0,1]
    v_pk_add_f32 v[20:21], v[28:29], v[96:97] op_sel:[0,1] op_sel_hi:[1,0] neg_lo:[0,1] neg_hi:[0,0]
    v_pk_add_f32 v[28:29], v[28:29], v[96:97] op_sel:[0,1] op_sel_hi:[1,0] neg_lo:[0,0] neg_hi:[0,1]
    v_pk_add_f32 v[114:115], v[114:115], v[114:115] op_sel:[0,1] op_sel_hi:[1,0] neg_lo:[0,1] neg_hi:[0,0]
    v_pk_add_f32 v[100:101], v[100:101], v[100:101] op_sel:[0,1] op_sel_hi:[1,0] neg_lo:[1,1] neg_hi:[1,0]
    v_pk_add_f32 v[110:111], v[114:115], v[100:101] neg_lo:[0,1] neg_hi:[0,1]
    v_pk_add_f32 v[114:115], v[114:115], v[100:101]
    v_pk_fma_f32 v[22:23], v[114:115], s[36:37], v[20:21]
    v_pk_fma_f32 v[20:21], v[114:115], s[36:37], v[20:21] neg_lo:[1,0,0] neg_hi:[1,0,0]
    v_pk_fma_f32 v[102:103], v[110:111], s[36:37], v[28:29] op_sel:[1,0,0] op_sel_hi:[0,1,1] neg_lo:[1,0,0]
    v_pk_fma_f32 v[28:29], v[110:111], s[36:37], v[28:29] op_sel:[1,0,0] op_sel_hi:[0,1,1] neg_hi:[1,0,0]
    v_mov_b32 v2, s48
    v_mov_b32 v3, s49
    v_sub_f32 v2, 1.0, v2
    v_sub_f32 v3, 1.0, v3
    v_cvt_pk_bf16_f32 v2, v2, v3
    v_lshlrev_b32 v52, 16, v2
    v_and_b32 v53, s32, v2
    s_waitcnt vmcnt(0)
    v_cvt_pk_bf16_f32 v2, v16, v17
    v_lshlrev_b32 v30, 16, v2
    v_and_b32 v31, s32, v2
    v_pk_mul_f32 v[30:31], v[30:31], s[48:49]
    v_lshlrev_b32 v98, 16, v36
    v_lshlrev_b32 v99, 16, v37
    v_pk_mul_f32 v[98:99], v[98:99], v[52:53]
    v_cvt_pk_bf16_f32 v2, v30, v31
    v_cvt_pk_bf16_f32 v3, v98, v99
    v_lshlrev_b32 v30, 16, v2
    v_and_b32 v31, s32, v2
    v_lshlrev_b32 v98, 16, v3
    v_and_b32 v99, s32, v3
    v_pk_add_f32 v[30:31], v[30:31], v[98:99]
    v_cvt_pk_bf16_f32 v16, v30, v31
    buffer_store_short v16, v11, s[44:47], 0 offen offset:0
    buffer_store_short_d16_hi v16, v11, s[44:47], 0 offen offset:1024
    v_cvt_pk_bf16_f32 v2, v22, v23
    v_lshlrev_b32 v18, 16, v2
    v_and_b32 v19, s32, v2
    v_pk_mul_f32 v[18:19], v[18:19], s[48:49]
    v_lshlrev_b32 v108, 16, v38
    v_lshlrev_b32 v109, 16, v39
    v_pk_mul_f32 v[108:109], v[108:109], v[52:53]
    v_cvt_pk_bf16_f32 v2, v18, v19
    v_cvt_pk_bf16_f32 v3, v108, v109
    v_lshlrev_b32 v18, 16, v2
    v_and_b32 v19, s32, v2
    v_lshlrev_b32 v108, 16, v3
    v_and_b32 v109, s32, v3
    v_pk_add_f32 v[18:19], v[18:19], v[108:109]
    v_cvt_pk_bf16_f32 v22, v18, v19
    buffer_store_short v22, v11, s[44:47], 0 offen offset:128
    buffer_store_short_d16_hi v22, v11, s[44:47], 0 offen offset:1152
    v_cvt_pk_bf16_f32 v2, v24, v25
    v_lshlrev_b32 v104, 16, v2
    v_and_b32 v105, s32, v2
    v_pk_mul_f32 v[104:105], v[104:105], s[48:49]
    v_lshlrev_b32 v106, 16, v40
    v_lshlrev_b32 v107, 16, v41
    v_pk_mul_f32 v[106:107], v[106:107], v[52:53]
    v_cvt_pk_bf16_f32 v2, v104, v105
    v_cvt_pk_bf16_f32 v3, v106, v107
    v_lshlrev_b32 v104, 16, v2
    v_and_b32 v105, s32, v2
    v_lshlrev_b32 v106, 16, v3
    v_and_b32 v107, s32, v3
    v_pk_add_f32 v[104:105], v[104:105], v[106:107]
    v_cvt_pk_bf16_f32 v24, v104, v105
    buffer_store_short v24, v11, s[44:47], 0 offen offset:256
    buffer_store_short_d16_hi v24, v11, s[44:47], 0 offen offset:1280
    v_cvt_pk_bf16_f32 v2, v102, v103
    v_lshlrev_b32 v96, 16, v2
    v_and_b32 v97, s32, v2
    v_pk_mul_f32 v[96:97], v[96:97], s[48:49]
    v_lshlrev_b32 v100, 16, v42
    v_lshlrev_b32 v101, 16, v43
    v_pk_mul_f32 v[100:101], v[100:101], v[52:53]
    v_cvt_pk_bf16_f32 v2, v96, v97
    v_cvt_pk_bf16_f32 v3, v100, v101
    v_lshlrev_b32 v96, 16, v2
    v_and_b32 v97, s32, v2
    v_lshlrev_b32 v100, 16, v3
    v_and_b32 v101, s32, v3
    v_pk_add_f32 v[96:97], v[96:97], v[100:101]
    v_cvt_pk_bf16_f32 v102, v96, v97
    buffer_store_short v102, v11, s[44:47], 0 offen offset:384
    buffer_store_short_d16_hi v102, v11, s[44:47], 0 offen offset:1408
    v_cvt_pk_bf16_f32 v2, v26, v27
    v_lshlrev_b32 v114, 16, v2
    v_and_b32 v115, s32, v2
    v_pk_mul_f32 v[114:115], v[114:115], s[48:49]
    v_lshlrev_b32 v110, 16, v44
    v_lshlrev_b32 v111, 16, v45
    v_pk_mul_f32 v[110:111], v[110:111], v[52:53]
    v_cvt_pk_bf16_f32 v2, v114, v115
    v_cvt_pk_bf16_f32 v3, v110, v111
    v_lshlrev_b32 v114, 16, v2
    v_and_b32 v115, s32, v2
    v_lshlrev_b32 v110, 16, v3
    v_and_b32 v111, s32, v3
    v_pk_add_f32 v[114:115], v[114:115], v[110:111]
    v_cvt_pk_bf16_f32 v26, v114, v115
    buffer_store_short v26, v11, s[44:47], 0 offen offset:512
    buffer_store_short_d16_hi v26, v11, s[44:47], 0 offen offset:1536
    v_cvt_pk_bf16_f32 v2, v20, v21
    v_lshlrev_b32 v30, 16, v2
    v_and_b32 v31, s32, v2
    v_pk_mul_f32 v[30:31], v[30:31], s[48:49]
    v_lshlrev_b32 v98, 16, v46
    v_lshlrev_b32 v99, 16, v47
    v_pk_mul_f32 v[98:99], v[98:99], v[52:53]
    v_cvt_pk_bf16_f32 v2, v30, v31
    v_cvt_pk_bf16_f32 v3, v98, v99
    v_lshlrev_b32 v30, 16, v2
    v_and_b32 v31, s32, v2
    v_lshlrev_b32 v98, 16, v3
    v_and_b32 v99, s32, v3
    v_pk_add_f32 v[30:31], v[30:31], v[98:99]
    v_cvt_pk_bf16_f32 v20, v30, v31
    buffer_store_short v20, v11, s[44:47], 0 offen offset:640
    buffer_store_short_d16_hi v20, v11, s[44:47], 0 offen offset:1664
    v_cvt_pk_bf16_f32 v2, v112, v113
    v_lshlrev_b32 v18, 16, v2
    v_and_b32 v19, s32, v2
    v_pk_mul_f32 v[18:19], v[18:19], s[48:49]
    v_lshlrev_b32 v108, 16, v48
    v_lshlrev_b32 v109, 16, v49
    v_pk_mul_f32 v[108:109], v[108:109], v[52:53]
    v_cvt_pk_bf16_f32 v2, v18, v19
    v_cvt_pk_bf16_f32 v3, v108, v109
    v_lshlrev_b32 v18, 16, v2
    v_and_b32 v19, s32, v2
    v_lshlrev_b32 v108, 16, v3
    v_and_b32 v109, s32, v3
    v_pk_add_f32 v[18:19], v[18:19], v[108:109]
    v_cvt_pk_bf16_f32 v112, v18, v19
    buffer_store_short v112, v11, s[44:47], 0 offen offset:768
    buffer_store_short_d16_hi v112, v11, s[44:47], 0 offen offset:1792
    v_cvt_pk_bf16_f32 v2, v28, v29
    v_lshlrev_b32 v104, 16, v2
    v_and_b32 v105, s32, v2
    v_pk_mul_f32 v[104:105], v[104:105], s[48:49]
    v_lshlrev_b32 v106, 16, v50
    v_lshlrev_b32 v107, 16, v51
    v_pk_mul_f32 v[106:107], v[106:107], v[52:53]
    v_cvt_pk_bf16_f32 v2, v104, v105
    v_cvt_pk_bf16_f32 v3, v106, v107
    v_lshlrev_b32 v104, 16, v2
    v_and_b32 v105, s32, v2
    v_lshlrev_b32 v106, 16, v3
    v_and_b32 v107, s32, v3
    v_pk_add_f32 v[104:105], v[104:105], v[106:107]
    v_cvt_pk_bf16_f32 v28, v104, v105
    buffer_store_short v28, v11, s[44:47], 0 offen offset:896
    buffer_store_short_d16_hi v28, v11, s[44:47], 0 offen offset:1920
K3_end:
    s_endpgm
.section .rodata,"a"
.p2align 6
.amdhsa_kernel gm_k1_kernel
  .amdhsa_next_free_vgpr 212
  .amdhsa_next_free_sgpr 102
  .amdhsa_accum_offset 212
  .amdhsa_group_segment_fixed_size 0
  .amdhsa_kernarg_size 88
  .amdhsa_user_sgpr_count 2
  .amdhsa_user_sgpr_kernarg_segment_ptr 1
  .amdhsa_system_sgpr_workgroup_id_x 1
  .amdhsa_float_denorm_mode_32 3
.end_amdhsa_kernel
.p2align 6
.amdhsa_kernel gm_k2_kernel
  .amdhsa_next_free_vgpr 232
  .amdhsa_next_free_sgpr 102
  .amdhsa_accum_offset 232
  .amdhsa_group_segment_fixed_size 0
  .amdhsa_kernarg_size 88
  .amdhsa_user_sgpr_count 2
  .amdhsa_user_sgpr_kernarg_segment_ptr 1
  .amdhsa_system_sgpr_workgroup_id_x 1
  .amdhsa_float_denorm_mode_32 3
.end_amdhsa_kernel
.p2align 6
.amdhsa_kernel gm_k3_kernel
  .amdhsa_next_free_vgpr 120
  .amdhsa_next_free_sgpr 102
  .amdhsa_accum_offset 120
  .amdhsa_group_segment_fixed_size 0
  .amdhsa_kernarg_size 88
  .amdhsa_user_sgpr_count 2
  .amdhsa_user_sgpr_kernarg_segment_ptr 1
  .amdhsa_system_sgpr_workgroup_id_x 1
  .amdhsa_float_denorm_mode_32 3
.end_amdhsa_kernel
```
